```python
import torch

def _softmax(x, axis=-1):
    return torch.softmax(x, dim=axis)

def _gelu(x):
    return torch.nn.functional.gelu(x, approximate='tanh')

def _silu(x):
    return torch.nn.functional.silu(x)

def _sigmoid(x):
    return torch.sigmoid(x)

def _layernorm(x, axis=-1, eps=1e-05):
    m = x.mean(dim=axis, keepdim=True)
    v = x.var(dim=axis, keepdim=True, unbiased=False)
    return (x - m) / torch.sqrt(v + eps)

def _scatter_add(tgt, idx, src, axis=0):
    return tgt.clone().index_add_(axis, idx, src)

def _segment_sum(src, seg, n):
    out = torch.zeros((n,) + src.shape[1:], dtype=src.dtype)
    return out.index_add_(0, seg, src)

def _pad(x, pw):
    flat = tuple((v for pair in reversed(pw) for v in pair))
    return torch.nn.functional.pad(x, flat)
kernel_name = 'gated_mix__memory_aug_recurrent_mem_tr__moe_arch_mod__prompt'

def setup_inputs():

    _w = lambda a: (lambda t: t.to(torch.bfloat16) if t.is_floating_point() else t)(torch.as_tensor(a))

    def _A_setup():
        B, S, Dm = (1, 2048, 1024)
        H, Dh = (32, 128)
        M, seg = (8, 32)
        seg = min(seg, S)
        S = S // seg * seg
        return {'x': _w((lambda *s: torch.randn(*s, dtype=torch.bfloat16) * 0.05)(B, S, Dm)), 'mem0': _w((lambda *s: torch.randn(*s, dtype=torch.bfloat16) * 0.8)(B, M, Dm)), 'Wq': _w((lambda *s: torch.randn(*s, dtype=torch.bfloat16) * 3.2)(Dm, H, Dh) * Dm ** (-0.5)), 'Wk': _w((lambda *s: torch.randn(*s, dtype=torch.bfloat16) * 3.2)(Dm, H, Dh) * Dm ** (-0.5)), 'Wv': _w((lambda *s: torch.randn(*s, dtype=torch.bfloat16) * 0.8)(Dm, H, Dh) * Dm ** (-0.5)), 'Wo': _w((lambda *s: torch.randn(*s, dtype=torch.bfloat16) * 0.8)(H, Dh, Dm) * (H * Dh) ** (-0.5)), 'seg_len': seg}
    _A_in = _A_setup()

    def _B_setup():
        B, S, D, F, C = (1, 2048, 1024, 3584, 2)
        return {'x': _w((lambda *s: torch.randn(*s, dtype=torch.bfloat16) * 0.05)(B, S, D)), 'w_r': _w((lambda *s: torch.randn(*s, dtype=torch.bfloat16) * 1.6)(D)), 'w_gate': _w((lambda *s: torch.randn(*s, dtype=torch.bfloat16) * 0.2)(D, F)), 'w_up': _w((lambda *s: torch.randn(*s, dtype=torch.bfloat16) * 0.2)(D, F)), 'w_down': _w((lambda *s: torch.randn(*s, dtype=torch.bfloat16) * 0.2)(F, D))}
    _B_in = _B_setup()
    return {'A_x': _A_in['x'], 'A_mem0': _A_in['mem0'], 'A_Wq': _A_in['Wq'], 'A_Wk': _A_in['Wk'], 'A_Wv': _A_in['Wv'], 'A_Wo': _A_in['Wo'], 'A_seg_len': _A_in['seg_len'], 'B_x': _B_in['x'], 'B_w_r': _B_in['w_r'], 'B_w_gate': _B_in['w_gate'], 'B_w_up': _B_in['w_up'], 'B_w_down': _B_in['w_down'], 'gate_w': _w((lambda *s: torch.randn(*s, dtype=torch.bfloat16) * 0.05)(1024) * 16.0)}

def reference(A_x, A_mem0, A_Wq, A_Wk, A_Wv, A_Wo, A_seg_len, B_x, B_w_r, B_w_gate, B_w_up, B_w_down, gate_w):

    def _A_ref(x, mem0, Wq, Wk, Wv, Wo, seg_len):
        B, S, Dm = x.shape
        H, Dh = (Wq.shape[1], Wq.shape[2])
        M = mem0.shape[1]
        scale = Dh ** (-0.5)
        n_seg = S // seg_len
        L = M + seg_len
        idx = torch.arange(L)
        mask = (idx[:, None] < M) | (idx[:, None] >= idx[None, :])
        mem = mem0
        outs = []
        for s in range(n_seg):
            xs = x[:, s * seg_len:(s + 1) * seg_len, :].clone()
            h = torch.concatenate([mem, xs], axis=1)
            q = torch.einsum('btd,dhe->bhte', h, Wq)
            k = torch.einsum('btd,dhe->bhte', h, Wk)
            v = torch.einsum('btd,dhe->bhte', h, Wv)
            scores = torch.einsum('bhqe,bhke->bhqk', q, k) * scale
            scores = torch.where(mask[None, None], scores, -1000000000.0)
            p = _softmax(scores, axis=-1)
            o = torch.einsum('bhqk,bhke->bhqe', p, v)
            o = torch.einsum('bhte,hed->btd', o, Wo)
            mem = o[:, :M, :].clone()
            outs.append(o[:, M:, :])
        return torch.concatenate(outs, axis=1)

    def _B_ref(x, w_r, w_gate, w_up, w_down):
        B, S, D = x.shape
        C = 2
        r = x @ w_r
        idx = torch.argsort(-r, axis=-1)[:, :C]
        idx_e = (lambda x, n, axis: torch.repeat_interleave(x, n, dim=axis))(idx.reshape(B, C, 1), D, axis=2)
        x_sel = (lambda x, i, axis: torch.take_along_dim(x, i, dim=axis))(x, idx_e, axis=1)
        g = _silu(x_sel @ w_gate)
        u = x_sel @ w_up
        y = g * u @ w_down
        r_sel = _sigmoid((lambda x, i, axis: torch.take_along_dim(x, i, dim=axis))(r, idx, axis=1))
        y = y * r_sel.reshape(B, C, 1)
        b_off = (torch.arange(B) * S).reshape(B, 1)
        flat_idx = (idx + b_off).reshape(B * C)
        zero = (x * 0.0).reshape(B * S, D)
        upd = _scatter_add(zero, flat_idx, y.reshape(B * C, D), axis=0)
        return x + upd.reshape(B, S, D)
    x = A_x
    g = _sigmoid((x * gate_w).sum(-1, keepdims=True))
    a = _A_ref(x, A_mem0, A_Wq, A_Wk, A_Wv, A_Wo, A_seg_len)
    b = _B_ref(x, B_w_r, B_w_gate, B_w_up, B_w_down)
    return g * a + (1 - g) * b
```

```asm
; @launch grid=(256,1,1) block=(768,1,1) lds=163840
.amdgcn_target "amdgcn-amd-amdhsa--gfx950"
.text
.globl gated_mix__memory_aug_recurrent_mem_tr__moe_arch_mod__prompt_kernel
.p2align 8
.type gated_mix__memory_aug_recurrent_mem_tr__moe_arch_mod__prompt_kernel,@function
gated_mix__memory_aug_recurrent_mem_tr__moe_arch_mod__prompt_kernel:
  s_cmp_ge_u32 s2, 256
  s_cbranch_scc1 L_END
  s_load_dwordx16 s[32:47], s[0:1], 0
  s_load_dwordx16 s[48:63], s[0:1], 64
  v_lshrrev_b32 v2, 6, v0
  v_and_b32 v0, 63, v0
  v_readfirstlane_b32 s24, v2
  v_lshlrev_b32 v1, 4, v0
  s_and_b32 s64, s24, 3
  s_getreg_b32 s25, hwreg(HW_REG_XCC_ID)
  s_and_b32 s25, s25, 15
  s_waitcnt lgkmcnt(0)
  s_mov_b32 s20, s60
  s_and_b32 s21, s61, 0xffff
  s_mov_b32 s22, 256
  s_mov_b32 s23, 0x20000
  s_cmp_lt_u32 s24, 2
  s_cbranch_scc1 L_NCP
  s_cmp_ge_u32 s24, 9
  s_cbranch_scc1 L_NCP
  s_getpc_b64 s[72:73]
  s_sub_u32 s74, s24, 2
  s_lshl_b32 s74, s74, 12
  v_lshlrev_b32 v15, 6, v0
  v_add_u32 v15, s74, v15
  v_min_u32 v15, CODE_BYTES, v15
  global_load_dword v16, v15, s[72:73]
L_NCP:
  s_cmp_lg_u32 s24, 0
  s_cbranch_scc1 L_C00
  s_lshl_b32 s30, s25, 4
  s_mov_b64 exec, 1
  v_mov_b32 v14, 1
  v_mov_b32 v9, s30
  buffer_atomic_add v14, v9, s[20:23], 0 offen sc0
  s_mov_b64 exec, -1
L_C00:
  s_mov_b32 s4, s62
  s_and_b32 s5, s63, 0xffff
  s_mov_b32 s6, 268435456
  s_mov_b32 s7, 0x20000
  s_mov_b32 s8, s32
  s_and_b32 s9, s33, 0xffff
  s_mov_b32 s10, 4194304
  s_mov_b32 s11, 0x20000
  s_mov_b32 s16, s58
  s_and_b32 s17, s59, 0xffff
  s_mov_b32 s18, 4194304
  s_mov_b32 s19, 0x20000
  s_mov_b32 s90, 0x00ff00ff
  s_mov_b32 s91, 0x00ff00ff
  s_mov_b32 s92, -1
  s_mov_b32 s93, 0
  s_mov_b32 s94, 0
  s_mov_b32 s95, -1
  s_mov_b32 s96, 0x00ff00ff
  s_mov_b32 s97, 0
  s_add_u32 s69, s62, 4194303
  s_and_b32 s69, s69, 0xffe00000
  s_sub_u32 s69, s69, s62
  s_mov_b32 s67, 0
  s_mov_b32 s68, 0
  s_mov_b32 s27, 0
  v_mov_b32 v4, -1
  v_mov_b32 v5, -1
  v_mov_b32 v6, -1
  v_mov_b32 v7, -1
  s_cmp_ge_u32 s24, 8
  s_cbranch_scc1 L_PB
  s_lshl_b32 s30, s2, 14
  s_add_u32 s30, s30, s69
  s_lshl_b32 s31, s24, 10
  s_add_u32 s30, s30, s31
  s_add_u32 s31, s30, 8192
  s_cmp_lt_u32 s2, 64
  s_cbranch_scc1 L_PA
  s_cmp_lg_u32 s24, 1
  s_cbranch_scc1 L_PD
L_PA:
  buffer_store_dwordx4 v[4:7], v1, s[4:7], s30 offen sc1
  buffer_store_dwordx4 v[4:7], v1, s[4:7], s31 offen sc1
  s_branch L_PD
L_PB:
  s_mul_i32 s30, s2, 5120
  s_lshl_b32 s31, s64, 10
  s_add_u32 s31, s31, s30
  buffer_store_dwordx4 v[4:7], v1, s[4:7], s31 offen sc1
  s_cmp_lg_u32 s64, 0
  s_cbranch_scc1 L_PC
  s_add_u32 s31, s30, 4096
  buffer_store_dwordx4 v[4:7], v1, s[4:7], s31 offen sc1
  v_mov_b32 v8, 0
  v_mov_b32 v9, 163616
  ds_write_b32 v9, v8
L_PC:
  s_cmp_lg_u32 s64, 1
  s_cbranch_scc1 L_PC2
  s_lshr_b32 s31, s2, 2
  s_cmp_eq_u32 s31, 36
  s_cbranch_scc1 L_PD
  v_mov_b32 v8, 0
  v_lshlrev_b32 v9, 2, v0
  s_lshl_b32 s31, s2, 8
  s_add_u32 s31, s31, 1572864
  buffer_store_dword v8, v9, s[4:7], s31 offen sc1
  s_branch L_PD
L_PC2:
  s_cmp_lg_u32 s64, 2
  s_cbranch_scc1 L_PD
  s_lshl_b32 s31, s2, 2
  s_add_u32 s31, s31, 1609728
  s_mov_b64 exec, 1
  v_mov_b32 v8, 0
  buffer_store_dword v8, v8, s[4:7], s31 offen sc1
  s_mov_b64 exec, -1
L_PD:
  s_cmp_lg_u32 s24, 0
  s_cbranch_scc1 L_C0
  s_waitcnt vmcnt(0)
  v_readfirstlane_b32 s26, v14
  v_mov_b32 v8, s25
  v_mov_b32 v9, s26
  v_mov_b32 v12, 163584
  ds_write_b64 v12, v[8:9]
L_C0:
  s_cmp_lg_u32 s24, 1
  s_cbranch_scc1 L_C1
  s_waitcnt vmcnt(0)
  s_mov_b64 exec, 1
  v_mov_b32 v9, 0
  s_mov_b32 s72, 0x7fffffff
  s_mov_b32 s73, 0x7fffffff
  s_memtime s[74:75]
  s_waitcnt lgkmcnt(0)
  buffer_load_dword v8, v9, s[4:7], s30 offen offset:0 sc1
  s_waitcnt vmcnt(0)
  s_memtime s[76:77]
  s_waitcnt lgkmcnt(0)
  s_sub_u32 s76, s76, s74
  s_min_u32 s72, s72, s76
  s_memtime s[74:75]
  s_waitcnt lgkmcnt(0)
  buffer_load_dword v8, v9, s[4:7], s31 offen offset:0 sc1
  s_waitcnt vmcnt(0)
  s_memtime s[76:77]
  s_waitcnt lgkmcnt(0)
  s_sub_u32 s76, s76, s74
  s_min_u32 s73, s73, s76
  s_memtime s[74:75]
  s_waitcnt lgkmcnt(0)
  buffer_load_dword v8, v9, s[4:7], s30 offen offset:256 sc1
  s_waitcnt vmcnt(0)
  s_memtime s[76:77]
  s_waitcnt lgkmcnt(0)
  s_sub_u32 s76, s76, s74
  s_min_u32 s72, s72, s76
  s_memtime s[74:75]
  s_waitcnt lgkmcnt(0)
  buffer_load_dword v8, v9, s[4:7], s31 offen offset:256 sc1
  s_waitcnt vmcnt(0)
  s_memtime s[76:77]
  s_waitcnt lgkmcnt(0)
  s_sub_u32 s76, s76, s74
  s_min_u32 s73, s73, s76
  v_mov_b32 v10, -1
  buffer_store_dword v10, v9, s[4:7], s30 offen offset:0 sc1
  buffer_store_dword v10, v9, s[4:7], s31 offen offset:0 sc1
  buffer_store_dword v10, v9, s[4:7], s30 offen offset:256 sc1
  buffer_store_dword v10, v9, s[4:7], s31 offen offset:256 sc1
  s_cmp_lt_u32 s73, s72
  s_cselect_b32 s72, 1, 0
  s_lshr_b32 s73, s2, 7
  s_lshl_b32 s73, s73, 1
  s_add_u32 s72, s72, s73
  s_mul_i32 s72, s72, 5
  s_add_u32 s72, s72, 10
  s_lshl_b32 s72, 1, s72
  s_add_u32 s72, s72, 1
  v_mov_b32 v8, s72
  v_mov_b32 v12, 163592
  ds_write_b32 v12, v8
  s_mov_b64 exec, -1
L_C1:
  s_waitcnt vmcnt(0) lgkmcnt(0)
  s_barrier
  v_mov_b32 v12, 163584
  ds_read_b128 v[8:11], v12
  s_waitcnt lgkmcnt(0)
  v_readfirstlane_b32 s26, v9
  s_cmp_lg_u32 s24, 8
  s_cbranch_scc1 L_C2
  s_lshl_b32 s30, s25, 4
  s_add_u32 s30, s30, 4
  s_mov_b64 exec, 1
  v_mov_b32 v9, s30
  buffer_atomic_add v10, v9, s[20:23], 0 offen
  s_mov_b64 exec, -1
L_C2:
  s_and_b32 s25, s25, 7
  s_and_b32 s26, s26, 31
  s_cmp_lt_u32 s24, 8
  s_cbranch_scc1 L_GX_SKIP
  s_setprio 3
  v_lshrrev_b32 v2, 3, v0
  v_and_b32 v3, 7, v0
  v_lshlrev_b32 v4, 11, v3
  v_lshl_add_u32 v4, v2, 4, v4
  s_lshl_b32 s30, s2, 14
  s_lshl_b32 s31, s64, 9
  s_add_u32 s31, s31, s30
  buffer_load_dwordx4 v[56:59], v4, s[8:11], s31 offen offset:0
  buffer_load_dwordx4 v[60:63], v4, s[8:11], s31 offen offset:128
  buffer_load_dwordx4 v[64:67], v4, s[8:11], s31 offen offset:256
  buffer_load_dwordx4 v[68:71], v4, s[8:11], s31 offen offset:384
  v_lshlrev_b32 v5, 8, v2
  v_lshl_add_u32 v5, v3, 4, v5
  v_lshlrev_b32 v2, 5, v0
  s_lshl_b32 s31, s64, 12
  s_add_u32 s30, s30, s31
  buffer_load_dwordx4 v[16:19], v2, s[8:11], s30 offen offset:0
  buffer_load_dwordx4 v[20:23], v2, s[8:11], s30 offen offset:16
  buffer_load_dwordx4 v[24:27], v2, s[8:11], s30 offen offset:2048
  buffer_load_dwordx4 v[28:31], v2, s[8:11], s30 offen offset:2064
  s_mov_b32 s12, s56
  s_and_b32 s13, s57, 0xffff
  s_mov_b32 s14, 2048
  s_mov_b32 s15, 0x20000
  buffer_load_dwordx4 v[32:35], v2, s[12:15], 0 offen offset:0
  buffer_load_dwordx4 v[36:39], v2, s[12:15], 0 offen offset:16
  s_mov_b32 s12, s48
  s_and_b32 s13, s49, 0xffff
  s_mov_b32 s14, 2048
  s_mov_b32 s15, 0x20000
  buffer_load_dwordx4 v[40:43], v2, s[12:15], 0 offen offset:0
  buffer_load_dwordx4 v[44:47], v2, s[12:15], 0 offen offset:16
  s_lshr_b32 s30, s2, 1
  s_lshl_b32 s30, s30, 15
  s_and_b32 s31, s2, 1
  s_lshl_b32 s31, s31, 7
  s_add_u32 s30, s30, s31
  s_lshl_b32 s31, s64, 13
  s_add_u32 s30, s30, s31
  s_add_u32 s30, s30, 25165824
  s_add_u32 s31, s30, 4096
  v_mov_b32 v8, 0
  v_mov_b32 v9, 0
  v_mov_b32 v10, 0
  v_mov_b32 v11, 0
  s_waitcnt vmcnt(8)
  buffer_store_dwordx4 v[56:59], v5, s[4:7], s30 offen offset:0 sc1
  buffer_store_dwordx4 v[60:63], v5, s[4:7], s30 offen offset:2048 sc1
  buffer_store_dwordx4 v[64:67], v5, s[4:7], s31 offen offset:0 sc1
  buffer_store_dwordx4 v[68:71], v5, s[4:7], s31 offen offset:2048 sc1
  s_waitcnt vmcnt(4)
  v_dot2_f32_bf16 v8, v16, v32, v8
  v_dot2_f32_bf16 v10, v16, v40, v10
  v_dot2_f32_bf16 v9, v24, v32, v9
  v_dot2_f32_bf16 v11, v24, v40, v11
  v_dot2_f32_bf16 v8, v17, v33, v8
  v_dot2_f32_bf16 v10, v17, v41, v10
  v_dot2_f32_bf16 v9, v25, v33, v9
  v_dot2_f32_bf16 v11, v25, v41, v11
  v_dot2_f32_bf16 v8, v18, v34, v8
  v_dot2_f32_bf16 v10, v18, v42, v10
  v_dot2_f32_bf16 v9, v26, v34, v9
  v_dot2_f32_bf16 v11, v26, v42, v11
  v_dot2_f32_bf16 v8, v19, v35, v8
  v_dot2_f32_bf16 v10, v19, v43, v10
  v_dot2_f32_bf16 v9, v27, v35, v9
  v_dot2_f32_bf16 v11, v27, v43, v11
  v_dot2_f32_bf16 v8, v20, v36, v8
  v_dot2_f32_bf16 v10, v20, v44, v10
  v_dot2_f32_bf16 v9, v28, v36, v9
  v_dot2_f32_bf16 v11, v28, v44, v11
  v_dot2_f32_bf16 v8, v21, v37, v8
  v_dot2_f32_bf16 v10, v21, v45, v10
  v_dot2_f32_bf16 v9, v29, v37, v9
  v_dot2_f32_bf16 v11, v29, v45, v11
  v_dot2_f32_bf16 v8, v22, v38, v8
  v_dot2_f32_bf16 v10, v22, v46, v10
  v_dot2_f32_bf16 v9, v30, v38, v9
  v_dot2_f32_bf16 v11, v30, v46, v11
  v_dot2_f32_bf16 v8, v23, v39, v8
  v_dot2_f32_bf16 v10, v23, v47, v10
  v_dot2_f32_bf16 v9, v31, v39, v9
  v_dot2_f32_bf16 v11, v31, v47, v11
  s_nop 2
  s_nop 1
  v_add_f32_dpp v8, v8, v8 row_ror:8 row_mask:0xf bank_mask:0xf
  v_add_f32_dpp v9, v9, v9 row_ror:8 row_mask:0xf bank_mask:0xf
  v_add_f32_dpp v10, v10, v10 row_ror:8 row_mask:0xf bank_mask:0xf
  v_add_f32_dpp v11, v11, v11 row_ror:8 row_mask:0xf bank_mask:0xf
  s_nop 1
  v_add_f32_dpp v8, v8, v8 row_ror:4 row_mask:0xf bank_mask:0xf
  v_add_f32_dpp v9, v9, v9 row_ror:4 row_mask:0xf bank_mask:0xf
  v_add_f32_dpp v10, v10, v10 row_ror:4 row_mask:0xf bank_mask:0xf
  v_add_f32_dpp v11, v11, v11 row_ror:4 row_mask:0xf bank_mask:0xf
  s_nop 1
  v_add_f32_dpp v8, v8, v8 row_ror:2 row_mask:0xf bank_mask:0xf
  v_add_f32_dpp v9, v9, v9 row_ror:2 row_mask:0xf bank_mask:0xf
  v_add_f32_dpp v10, v10, v10 row_ror:2 row_mask:0xf bank_mask:0xf
  v_add_f32_dpp v11, v11, v11 row_ror:2 row_mask:0xf bank_mask:0xf
  s_nop 1
  v_add_f32_dpp v8, v8, v8 row_ror:1 row_mask:0xf bank_mask:0xf
  v_add_f32_dpp v9, v9, v9 row_ror:1 row_mask:0xf bank_mask:0xf
  v_add_f32_dpp v10, v10, v10 row_ror:1 row_mask:0xf bank_mask:0xf
  v_add_f32_dpp v11, v11, v11 row_ror:1 row_mask:0xf bank_mask:0xf
  v_mov_b32 v12, v8
  s_nop 1
  v_permlane16_swap_b32 v8, v12
  s_nop 1
  v_add_f32 v8, v8, v12
  v_mov_b32 v12, v9
  s_nop 1
  v_permlane16_swap_b32 v9, v12
  s_nop 1
  v_add_f32 v9, v9, v12
  v_mov_b32 v12, v10
  s_nop 1
  v_permlane16_swap_b32 v10, v12
  s_nop 1
  v_add_f32 v10, v10, v12
  v_mov_b32 v12, v11
  s_nop 1
  v_permlane16_swap_b32 v11, v12
  s_nop 1
  v_add_f32 v11, v11, v12
  v_mov_b32 v12, v8
  s_nop 1
  v_permlane32_swap_b32 v8, v12
  s_nop 1
  v_add_f32 v8, v8, v12
  v_mov_b32 v12, v9
  s_nop 1
  v_permlane32_swap_b32 v9, v12
  s_nop 1
  v_add_f32 v9, v9, v12
  v_mov_b32 v12, v10
  s_nop 1
  v_permlane32_swap_b32 v10, v12
  s_nop 1
  v_add_f32 v10, v10, v12
  v_mov_b32 v12, v11
  s_nop 1
  v_permlane32_swap_b32 v11, v12
  s_nop 1
  v_add_f32 v11, v11, v12
  v_cvt_pk_bf16_f32 v12, v8, v9
  v_cvt_pk_bf16_f32 v13, v10, v11
  v_lshlrev_b32 v8, 16, v12
  v_and_b32 v9, 0xffff0000, v12
  v_lshlrev_b32 v10, 16, v13
  v_and_b32 v11, 0xffff0000, v13
  v_mul_f32 v8, 0xbfb8aa3b, v8
  v_exp_f32 v8, v8
  s_nop 0
  v_add_f32 v8, 1.0, v8
  v_rcp_f32 v8, v8
  s_nop 0
  v_mul_f32 v9, 0xbfb8aa3b, v9
  v_exp_f32 v9, v9
  s_nop 0
  v_add_f32 v9, 1.0, v9
  v_rcp_f32 v9, v9
  s_nop 0
  v_cvt_pk_bf16_f32 v12, v8, v9
  v_lshlrev_b32 v8, 16, v12
  v_and_b32 v9, 0xffff0000, v12
  s_lshl_b32 s30, s2, 5
  s_lshl_b32 s31, s64, 3
  s_add_u32 s30, s30, s31
  s_add_u32 s30, s30, 8388608
  s_add_u32 s31, s30, 8192
  s_lshl_b32 s65, s2, 3
  s_lshl_b32 s66, s64, 1
  s_add_u32 s65, s65, s66
  s_sub_u32 s65, 0xffff, s65
  s_sub_u32 s66, s65, 1
  v_ashrrev_i32 v14, 31, v10
  v_or_b32 v14, 0x80000000, v14
  v_xor_b32 v14, v14, v10
  v_and_b32 v14, 0xffff0000, v14
  v_or_b32 v14, s65, v14
  v_ashrrev_i32 v15, 31, v11
  v_or_b32 v15, 0x80000000, v15
  v_xor_b32 v15, v15, v11
  v_and_b32 v15, 0xffff0000, v15
  v_or_b32 v15, s66, v15
  s_add_u32 s65, s30, 16384
  s_mov_b64 exec, 1
  v_mov_b32 v12, 0
  buffer_store_dwordx2 v[8:9], v12, s[4:7], s30 offen sc1
  buffer_store_dwordx2 v[10:11], v12, s[4:7], s31 offen sc1
  buffer_store_dwordx2 v[14:15], v12, s[4:7], s65 offen sc1
  s_waitcnt vmcnt(0)
  v_mov_b32 v8, 1
  v_mov_b32 v9, 163616
  ds_add_rtn_u32 v10, v9, v8
  s_waitcnt lgkmcnt(0)
  v_readfirstlane_b32 s30, v10
  s_cmp_lg_u32 s30, 3
  s_cbranch_scc1 L_GX1
  s_lshl_b32 s30, s2, 2
  s_add_u32 s30, s30, 1609728
  v_mov_b32 v8, 100
  buffer_store_dword v8, v12, s[4:7], s30 offen sc1
L_GX1:
  s_mov_b64 exec, -1
  s_setprio 0
L_GX_SKIP:
L_WGT2:
L_WGT:
  s_and_b32 s71, s26, 15
  s_cmp_ge_u32 s24, 8
  s_cbranch_scc1 L_WG8
  s_lshl_b32 s66, s25, 10
  s_lshl_b32 s31, s71, 6
  s_add_u32 s66, s66, s31
  s_lshl_b32 s31, s24, 20
  s_add_u32 s66, s66, s31
  v_lshrrev_b32 v8, 2, v0
  v_and_b32 v9, 3, v0
  v_lshlrev_b32 v9, 4, v9
  v_lshlrev_b32 v11, 13, v8
  v_add_u32 v11, v11, v9
  s_lshl_b32 s65, s24, 13
  s_sleep 3
  s_cmp_ge_u32 s26, 16
  s_cbranch_scc1 L_WNS
  s_sleep 60
L_WNS:
  s_mov_b32 s12, s38
  s_and_b32 s13, s39, 0xffff
  s_mov_b32 s14, 8388608
  s_mov_b32 s15, 0x20000
  s_add_u32 s31, s66, 0
  s_add_u32 m0, s65, 0
  s_nop 0
  buffer_load_dwordx4 v11, s[12:15], s31 offen nt lds
  s_add_u32 s31, s66, 131072
  s_add_u32 m0, s65, 1024
  s_nop 0
  buffer_load_dwordx4 v11, s[12:15], s31 offen nt lds
  s_add_u32 s31, s66, 262144
  s_add_u32 m0, s65, 2048
  s_nop 0
  buffer_load_dwordx4 v11, s[12:15], s31 offen nt lds
  s_add_u32 s31, s66, 393216
  s_add_u32 m0, s65, 3072
  s_nop 0
  buffer_load_dwordx4 v11, s[12:15], s31 offen nt lds
  s_add_u32 s31, s66, 524288
  s_add_u32 m0, s65, 4096
  s_nop 0
  buffer_load_dwordx4 v11, s[12:15], s31 offen nt lds
  s_add_u32 s31, s66, 655360
  s_add_u32 m0, s65, 5120
  s_nop 0
  buffer_load_dwordx4 v11, s[12:15], s31 offen nt lds
  s_add_u32 s31, s66, 786432
  s_add_u32 m0, s65, 6144
  s_nop 0
  buffer_load_dwordx4 v11, s[12:15], s31 offen nt lds
  s_add_u32 s31, s66, 917504
  s_add_u32 m0, s65, 7168
  s_nop 0
  buffer_load_dwordx4 v11, s[12:15], s31 offen nt lds
  s_mov_b32 s12, s40
  s_and_b32 s13, s41, 0xffff
  s_mov_b32 s14, 8388608
  s_mov_b32 s15, 0x20000
  s_add_u32 s31, s66, 0
  s_add_u32 m0, s65, 65536
  s_nop 0
  buffer_load_dwordx4 v11, s[12:15], s31 offen nt lds
  s_add_u32 s31, s66, 131072
  s_add_u32 m0, s65, 66560
  s_nop 0
  buffer_load_dwordx4 v11, s[12:15], s31 offen nt lds
  s_add_u32 s31, s66, 262144
  s_add_u32 m0, s65, 67584
  s_nop 0
  buffer_load_dwordx4 v11, s[12:15], s31 offen nt lds
  s_add_u32 s31, s66, 393216
  s_add_u32 m0, s65, 68608
  s_nop 0
  buffer_load_dwordx4 v11, s[12:15], s31 offen nt lds
  s_add_u32 s31, s66, 524288
  s_add_u32 m0, s65, 69632
  s_nop 0
  buffer_load_dwordx4 v11, s[12:15], s31 offen nt lds
  s_add_u32 s31, s66, 655360
  s_add_u32 m0, s65, 70656
  s_nop 0
  buffer_load_dwordx4 v11, s[12:15], s31 offen nt lds
  s_add_u32 s31, s66, 786432
  s_add_u32 m0, s65, 71680
  s_nop 0
  buffer_load_dwordx4 v11, s[12:15], s31 offen nt lds
  s_add_u32 s31, s66, 917504
  s_add_u32 m0, s65, 72704
  s_nop 0
  buffer_load_dwordx4 v11, s[12:15], s31 offen nt lds
  s_cmp_ge_u32 s26, 16
  s_cbranch_scc1 L_WGB
  v_lshrrev_b32 v9, 4, v0
  v_lshlrev_b32 v9, 2, v9
  v_bfe_u32 v10, v0, 3, 1
  v_lshl_add_u32 v9, v10, 5, v9
  v_bfe_u32 v10, v0, 2, 1
  v_add_u32 v9, v9, v10
  v_lshlrev_b32 v9, 6, v9
  v_and_b32 v10, 3, v0
  v_lshl_add_u32 v9, v10, 3, v9
  v_add_u32 v9, s65, v9
  v_add_u32 v10, 0x10000, v9
  s_waitcnt vmcnt(8)
  ds_read_b64_tr_b16 v[72:73], v9 offset:0
  ds_read_b64_tr_b16 v[74:75], v9 offset:128
  ds_read_b64_tr_b16 v[76:77], v9 offset:1024
  ds_read_b64_tr_b16 v[78:79], v9 offset:1152
  ds_read_b64_tr_b16 v[80:81], v9 offset:4096
  ds_read_b64_tr_b16 v[82:83], v9 offset:4224
  ds_read_b64_tr_b16 v[84:85], v9 offset:5120
  ds_read_b64_tr_b16 v[86:87], v9 offset:5248
  ds_read_b64_tr_b16 v[88:89], v9 offset:32
  ds_read_b64_tr_b16 v[90:91], v9 offset:160
  ds_read_b64_tr_b16 v[92:93], v9 offset:1056
  ds_read_b64_tr_b16 v[94:95], v9 offset:1184
  ds_read_b64_tr_b16 v[96:97], v9 offset:4128
  ds_read_b64_tr_b16 v[98:99], v9 offset:4256
  ds_read_b64_tr_b16 v[100:101], v9 offset:5152
  ds_read_b64_tr_b16 v[102:103], v9 offset:5280
  s_waitcnt lgkmcnt(0)
  s_mov_b32 s12, s36
  s_and_b32 s13, s37, 0xffff
  s_mov_b32 s14, 8388608
  s_mov_b32 s15, 0x20000
  s_add_u32 s31, s66, 0
  s_add_u32 m0, s65, 0
  s_nop 0
  buffer_load_dwordx4 v11, s[12:15], s31 offen nt lds
  s_add_u32 s31, s66, 131072
  s_add_u32 m0, s65, 1024
  s_nop 0
  buffer_load_dwordx4 v11, s[12:15], s31 offen nt lds
  s_add_u32 s31, s66, 262144
  s_add_u32 m0, s65, 2048
  s_nop 0
  buffer_load_dwordx4 v11, s[12:15], s31 offen nt lds
  s_add_u32 s31, s66, 393216
  s_add_u32 m0, s65, 3072
  s_nop 0
  buffer_load_dwordx4 v11, s[12:15], s31 offen nt lds
  s_add_u32 s31, s66, 524288
  s_add_u32 m0, s65, 4096
  s_nop 0
  buffer_load_dwordx4 v11, s[12:15], s31 offen nt lds
  s_add_u32 s31, s66, 655360
  s_add_u32 m0, s65, 5120
  s_nop 0
  buffer_load_dwordx4 v11, s[12:15], s31 offen nt lds
  s_add_u32 s31, s66, 786432
  s_add_u32 m0, s65, 6144
  s_nop 0
  buffer_load_dwordx4 v11, s[12:15], s31 offen nt lds
  s_add_u32 s31, s66, 917504
  s_add_u32 m0, s65, 7168
  s_nop 0
  buffer_load_dwordx4 v11, s[12:15], s31 offen nt lds
  s_waitcnt vmcnt(8)
  ds_read_b64_tr_b16 v[104:105], v10 offset:0
  ds_read_b64_tr_b16 v[106:107], v10 offset:128
  ds_read_b64_tr_b16 v[108:109], v10 offset:1024
  ds_read_b64_tr_b16 v[110:111], v10 offset:1152
  ds_read_b64_tr_b16 v[112:113], v10 offset:4096
  ds_read_b64_tr_b16 v[114:115], v10 offset:4224
  ds_read_b64_tr_b16 v[116:117], v10 offset:5120
  ds_read_b64_tr_b16 v[118:119], v10 offset:5248
  ds_read_b64_tr_b16 v[120:121], v10 offset:32
  ds_read_b64_tr_b16 v[122:123], v10 offset:160
  ds_read_b64_tr_b16 v[124:125], v10 offset:1056
  ds_read_b64_tr_b16 v[126:127], v10 offset:1184
  ds_read_b64_tr_b16 v[128:129], v10 offset:4128
  ds_read_b64_tr_b16 v[130:131], v10 offset:4256
  ds_read_b64_tr_b16 v[132:133], v10 offset:5152
  ds_read_b64_tr_b16 v[134:135], v10 offset:5280
  s_waitcnt lgkmcnt(0)
  s_mov_b32 s12, s42
  s_and_b32 s13, s43, 0xffff
  s_mov_b32 s14, 8388608
  s_mov_b32 s15, 0x20000
  s_lshl_b32 s30, s25, 20
  s_lshl_b32 s31, s24, 17
  s_add_u32 s30, s30, s31
  s_lshl_b32 s31, s71, 7
  s_add_u32 s30, s30, s31
  v_lshrrev_b32 v8, 3, v0
  v_and_b32 v12, 7, v0
  v_lshlrev_b32 v12, 4, v12
  v_lshl_add_u32 v12, v8, 11, v12
  s_add_u32 s31, s30, 0
  s_add_u32 m0, s65, 65536
  s_nop 0
  buffer_load_dwordx4 v12, s[12:15], s31 offen nt lds
  s_add_u32 s31, s30, 16384
  s_add_u32 m0, s65, 66560
  s_nop 0
  buffer_load_dwordx4 v12, s[12:15], s31 offen nt lds
  s_add_u32 s31, s30, 32768
  s_add_u32 m0, s65, 67584
  s_nop 0
  buffer_load_dwordx4 v12, s[12:15], s31 offen nt lds
  s_add_u32 s31, s30, 49152
  s_add_u32 m0, s65, 68608
  s_nop 0
  buffer_load_dwordx4 v12, s[12:15], s31 offen nt lds
  s_add_u32 s31, s30, 65536
  s_add_u32 m0, s65, 69632
  s_nop 0
  buffer_load_dwordx4 v12, s[12:15], s31 offen nt lds
  s_add_u32 s31, s30, 81920
  s_add_u32 m0, s65, 70656
  s_nop 0
  buffer_load_dwordx4 v12, s[12:15], s31 offen nt lds
  s_add_u32 s31, s30, 98304
  s_add_u32 m0, s65, 71680
  s_nop 0
  buffer_load_dwordx4 v12, s[12:15], s31 offen nt lds
  s_add_u32 s31, s30, 114688
  s_add_u32 m0, s65, 72704
  s_nop 0
  buffer_load_dwordx4 v12, s[12:15], s31 offen nt lds
  s_waitcnt vmcnt(8)
  ds_read_b64_tr_b16 v[40:41], v9 offset:0
  ds_read_b64_tr_b16 v[42:43], v9 offset:128
  ds_read_b64_tr_b16 v[44:45], v9 offset:1024
  ds_read_b64_tr_b16 v[46:47], v9 offset:1152
  ds_read_b64_tr_b16 v[48:49], v9 offset:4096
  ds_read_b64_tr_b16 v[50:51], v9 offset:4224
  ds_read_b64_tr_b16 v[52:53], v9 offset:5120
  ds_read_b64_tr_b16 v[54:55], v9 offset:5248
  ds_read_b64_tr_b16 v[56:57], v9 offset:32
  ds_read_b64_tr_b16 v[58:59], v9 offset:160
  ds_read_b64_tr_b16 v[60:61], v9 offset:1056
  ds_read_b64_tr_b16 v[62:63], v9 offset:1184
  ds_read_b64_tr_b16 v[64:65], v9 offset:4128
  ds_read_b64_tr_b16 v[66:67], v9 offset:4256
  ds_read_b64_tr_b16 v[68:69], v9 offset:5152
  ds_read_b64_tr_b16 v[70:71], v9 offset:5280
  s_waitcnt lgkmcnt(0)
  s_branch L_WG8
L_WGB:
  v_lshrrev_b32 v9, 4, v0
  v_lshlrev_b32 v9, 3, v9
  v_bfe_u32 v10, v0, 2, 2
  v_add_u32 v9, v9, v10
  v_lshlrev_b32 v9, 6, v9
  v_and_b32 v10, 3, v0
  v_lshl_add_u32 v9, v10, 3, v9
  v_add_u32 v9, s65, v9
  v_add_u32 v10, 0x10000, v9
  s_waitcnt vmcnt(8)
  ds_read_b64_tr_b16 v[72:73], v9 offset:0
  ds_read_b64_tr_b16 v[74:75], v9 offset:256
  ds_read_b64_tr_b16 v[76:77], v9 offset:2048
  ds_read_b64_tr_b16 v[78:79], v9 offset:2304
  ds_read_b64_tr_b16 v[80:81], v9 offset:4096
  ds_read_b64_tr_b16 v[82:83], v9 offset:4352
  ds_read_b64_tr_b16 v[84:85], v9 offset:6144
  ds_read_b64_tr_b16 v[86:87], v9 offset:6400
  ds_read_b64_tr_b16 v[88:89], v9 offset:32
  ds_read_b64_tr_b16 v[90:91], v9 offset:288
  ds_read_b64_tr_b16 v[92:93], v9 offset:2080
  ds_read_b64_tr_b16 v[94:95], v9 offset:2336
  ds_read_b64_tr_b16 v[96:97], v9 offset:4128
  ds_read_b64_tr_b16 v[98:99], v9 offset:4384
  ds_read_b64_tr_b16 v[100:101], v9 offset:6176
  ds_read_b64_tr_b16 v[102:103], v9 offset:6432
  s_waitcnt lgkmcnt(0)
  s_mov_b32 s12, s36
  s_and_b32 s13, s37, 0xffff
  s_mov_b32 s14, 8388608
  s_mov_b32 s15, 0x20000
  s_add_u32 s31, s66, 0
  s_add_u32 m0, s65, 0
  s_nop 0
  buffer_load_dwordx4 v11, s[12:15], s31 offen nt lds
  s_add_u32 s31, s66, 131072
  s_add_u32 m0, s65, 1024
  s_nop 0
  buffer_load_dwordx4 v11, s[12:15], s31 offen nt lds
  s_add_u32 s31, s66, 262144
  s_add_u32 m0, s65, 2048
  s_nop 0
  buffer_load_dwordx4 v11, s[12:15], s31 offen nt lds
  s_add_u32 s31, s66, 393216
  s_add_u32 m0, s65, 3072
  s_nop 0
  buffer_load_dwordx4 v11, s[12:15], s31 offen nt lds
  s_add_u32 s31, s66, 524288
  s_add_u32 m0, s65, 4096
  s_nop 0
  buffer_load_dwordx4 v11, s[12:15], s31 offen nt lds
  s_add_u32 s31, s66, 655360
  s_add_u32 m0, s65, 5120
  s_nop 0
  buffer_load_dwordx4 v11, s[12:15], s31 offen nt lds
  s_add_u32 s31, s66, 786432
  s_add_u32 m0, s65, 6144
  s_nop 0
  buffer_load_dwordx4 v11, s[12:15], s31 offen nt lds
  s_add_u32 s31, s66, 917504
  s_add_u32 m0, s65, 7168
  s_nop 0
  buffer_load_dwordx4 v11, s[12:15], s31 offen nt lds
  s_waitcnt vmcnt(8)
  ds_read_b64_tr_b16 v[104:105], v10 offset:0
  ds_read_b64_tr_b16 v[106:107], v10 offset:256
  ds_read_b64_tr_b16 v[108:109], v10 offset:2048
  ds_read_b64_tr_b16 v[110:111], v10 offset:2304
  ds_read_b64_tr_b16 v[112:113], v10 offset:4096
  ds_read_b64_tr_b16 v[114:115], v10 offset:4352
  ds_read_b64_tr_b16 v[116:117], v10 offset:6144
  ds_read_b64_tr_b16 v[118:119], v10 offset:6400
  ds_read_b64_tr_b16 v[120:121], v10 offset:32
  ds_read_b64_tr_b16 v[122:123], v10 offset:288
  ds_read_b64_tr_b16 v[124:125], v10 offset:2080
  ds_read_b64_tr_b16 v[126:127], v10 offset:2336
  ds_read_b64_tr_b16 v[128:129], v10 offset:4128
  ds_read_b64_tr_b16 v[130:131], v10 offset:4384
  ds_read_b64_tr_b16 v[132:133], v10 offset:6176
  ds_read_b64_tr_b16 v[134:135], v10 offset:6432
  s_waitcnt lgkmcnt(0)
  s_mov_b32 s12, s42
  s_and_b32 s13, s43, 0xffff
  s_mov_b32 s14, 8388608
  s_mov_b32 s15, 0x20000
  s_lshl_b32 s30, s25, 20
  s_lshl_b32 s31, s24, 17
  s_add_u32 s30, s30, s31
  s_lshl_b32 s31, s71, 7
  s_add_u32 s30, s30, s31
  v_lshrrev_b32 v8, 3, v0
  v_and_b32 v12, 7, v0
  v_lshlrev_b32 v12, 4, v12
  v_lshl_add_u32 v12, v8, 11, v12
  s_add_u32 s31, s30, 0
  s_add_u32 m0, s65, 65536
  s_nop 0
  buffer_load_dwordx4 v12, s[12:15], s31 offen nt lds
  s_add_u32 s31, s30, 16384
  s_add_u32 m0, s65, 66560
  s_nop 0
  buffer_load_dwordx4 v12, s[12:15], s31 offen nt lds
  s_add_u32 s31, s30, 32768
  s_add_u32 m0, s65, 67584
  s_nop 0
  buffer_load_dwordx4 v12, s[12:15], s31 offen nt lds
  s_add_u32 s31, s30, 49152
  s_add_u32 m0, s65, 68608
  s_nop 0
  buffer_load_dwordx4 v12, s[12:15], s31 offen nt lds
  s_add_u32 s31, s30, 65536
  s_add_u32 m0, s65, 69632
  s_nop 0
  buffer_load_dwordx4 v12, s[12:15], s31 offen nt lds
  s_add_u32 s31, s30, 81920
  s_add_u32 m0, s65, 70656
  s_nop 0
  buffer_load_dwordx4 v12, s[12:15], s31 offen nt lds
  s_add_u32 s31, s30, 98304
  s_add_u32 m0, s65, 71680
  s_nop 0
  buffer_load_dwordx4 v12, s[12:15], s31 offen nt lds
  s_add_u32 s31, s30, 114688
  s_add_u32 m0, s65, 72704
  s_nop 0
  buffer_load_dwordx4 v12, s[12:15], s31 offen nt lds
  s_waitcnt vmcnt(8)
  ds_read_b64_tr_b16 v[40:41], v9 offset:0
  ds_read_b64_tr_b16 v[42:43], v9 offset:256
  ds_read_b64_tr_b16 v[44:45], v9 offset:2048
  ds_read_b64_tr_b16 v[46:47], v9 offset:2304
  ds_read_b64_tr_b16 v[48:49], v9 offset:4096
  ds_read_b64_tr_b16 v[50:51], v9 offset:4352
  ds_read_b64_tr_b16 v[52:53], v9 offset:6144
  ds_read_b64_tr_b16 v[54:55], v9 offset:6400
  ds_read_b64_tr_b16 v[56:57], v9 offset:32
  ds_read_b64_tr_b16 v[58:59], v9 offset:288
  ds_read_b64_tr_b16 v[60:61], v9 offset:2080
  ds_read_b64_tr_b16 v[62:63], v9 offset:2336
  ds_read_b64_tr_b16 v[64:65], v9 offset:4128
  ds_read_b64_tr_b16 v[66:67], v9 offset:4384
  ds_read_b64_tr_b16 v[68:69], v9 offset:6176
  ds_read_b64_tr_b16 v[70:71], v9 offset:6432
  s_waitcnt lgkmcnt(0)
L_WG8:
  s_waitcnt vmcnt(0) lgkmcnt(0)
  s_barrier
  s_cmp_lg_u32 s24, 8
  s_cbranch_scc1 L_CP_SKIP
  v_and_b32 v9, 15, v0
  v_lshlrev_b32 v9, 4, v9
L_C3:
  buffer_load_dword v8, v9, s[20:23], 0 offen offset:4 sc1
  s_waitcnt vmcnt(0)
  v_and_b32 v10, 0x3ff, v8
  v_mov_b32 v11, v10
  s_nop 1
  v_add_u32_dpp v11, v11, v11 row_ror:8 row_mask:0xf bank_mask:0xf
  s_nop 1
  v_add_u32_dpp v11, v11, v11 row_ror:4 row_mask:0xf bank_mask:0xf
  s_nop 1
  v_add_u32_dpp v11, v11, v11 row_ror:2 row_mask:0xf bank_mask:0xf
  s_nop 1
  v_add_u32_dpp v11, v11, v11 row_ror:1 row_mask:0xf bank_mask:0xf
  s_nop 0
  v_readfirstlane_b32 s30, v11
  s_cmp_ge_u32 s30, 256
  s_cbranch_scc1 L_C4
  s_sleep 4
  s_add_u32 s67, s67, 1
  s_cmp_lt_u32 s67, 524288
  s_cbranch_scc1 L_C3
L_C4:
  v_bfe_u32 v12, v8, 10, 5
  v_bfe_u32 v13, v8, 15, 5
  v_cmp_gt_u32 vcc, v13, v12
  s_and_b32 s30, vcc_lo, 0xff
  v_bfe_u32 v12, v8, 20, 5
  v_bfe_u32 v13, v8, 25, 5
  v_cmp_gt_u32 vcc, v13, v12
  s_and_b32 s65, vcc_lo, 0xff
  s_bcnt1_i32_b32 s31, s30
  s_cmp_eq_u32 s31, 4
  s_cselect_b32 s30, s30, 0xf0
  s_bcnt1_i32_b32 s31, s65
  s_cmp_eq_u32 s31, 4
  s_cselect_b32 s65, s65, 0xf0
  s_lshl_b32 s65, s65, 8
  s_or_b32 s70, s30, s65
  v_cmp_eq_u32 vcc, 32, v10
  s_and_b32 s30, vcc_lo, 0xff
  s_mov_b32 s31, 0
  s_cmp_eq_u32 s30, 0xff
  s_cbranch_scc1 L_C5
  s_mov_b32 s31, 1
  s_mov_b32 s70, 0xf0f0
L_C5:
  v_mov_b32 v8, s31
  v_mov_b32 v9, s70
  v_mov_b32 v12, 163600
  ds_write_b64 v12, v[8:9]
L_CP_SKIP:
  s_waitcnt lgkmcnt(0)
  s_barrier
  v_mov_b32 v12, 163600
  ds_read_b64 v[8:9], v12
  s_waitcnt lgkmcnt(0)
  v_readfirstlane_b32 s30, v8
  v_readfirstlane_b32 s70, v9
  s_cmp_eq_u32 s30, s27
  s_cbranch_scc1 L_CAP
  s_mov_b32 s27, 1
  s_lshr_b32 s25, s2, 5
  s_and_b32 s26, s2, 31
  s_barrier
  s_branch L_WGT2
L_CAP:
  s_cmp_eq_u32 s27, 0
  s_cselect_b32 s20, 15, 63
  v_lshrrev_b32 v8, 4, v0
  v_lshlrev_b32 v8, 3, v8
  v_bfe_u32 v9, v0, 2, 2
  v_add_u32 v8, v8, v9
  v_lshlrev_b32 v12, 7, v8
  v_and_b32 v9, 3, v0
  v_lshl_add_u32 v12, v9, 3, v12
  s_cmp_ge_u32 s26, 16
  s_cbranch_scc1 L_G2B
  s_cmp_ge_u32 s24, 8
  s_cbranch_scc1 L_G2E
  v_lshrrev_b32 v9, 4, v0
  v_lshlrev_b32 v9, 2, v9
  v_bfe_u32 v10, v0, 3, 1
  v_lshl_add_u32 v9, v10, 6, v9
  v_bfe_u32 v10, v0, 2, 1
  v_add_u32 v9, v9, v10
  v_lshlrev_b32 v9, 7, v9
  v_and_b32 v10, 3, v0
  v_lshl_add_u32 v9, v10, 3, v9
  s_lshr_b32 s30, s24, 1
  s_lshl_b32 s30, s30, 14
  s_and_b32 s31, s24, 1
  s_lshl_b32 s31, s31, 12
  s_add_u32 s30, s30, s31
  s_add_u32 s30, s30, 65536
  v_add_u32 v10, s30, v9
  ds_read_b64_tr_b16 v[136:137], v10 offset:0
  ds_read_b64_tr_b16 v[138:139], v10 offset:256
  ds_read_b64_tr_b16 v[140:141], v10 offset:2048
  ds_read_b64_tr_b16 v[142:143], v10 offset:2304
  ds_read_b64_tr_b16 v[144:145], v10 offset:32
  ds_read_b64_tr_b16 v[146:147], v10 offset:288
  ds_read_b64_tr_b16 v[148:149], v10 offset:2080
  ds_read_b64_tr_b16 v[150:151], v10 offset:2336
  ds_read_b64_tr_b16 v[152:153], v10 offset:64
  ds_read_b64_tr_b16 v[154:155], v10 offset:320
  ds_read_b64_tr_b16 v[156:157], v10 offset:2112
  ds_read_b64_tr_b16 v[158:159], v10 offset:2368
  ds_read_b64_tr_b16 v[160:161], v10 offset:96
  ds_read_b64_tr_b16 v[162:163], v10 offset:352
  ds_read_b64_tr_b16 v[164:165], v10 offset:2144
  ds_read_b64_tr_b16 v[166:167], v10 offset:2400
  s_branch L_G2E
L_G2B:
  s_cmp_lt_u32 s24, 8
  s_cbranch_scc1 L_G2E
  s_lshl_b32 s30, s64, 14
  s_add_u32 s30, s30, 65536
  v_add_u32 v10, s30, v12
  ds_read_b64_tr_b16 v[104:105], v10 offset:0
  ds_read_b64_tr_b16 v[106:107], v10 offset:512
  ds_read_b64_tr_b16 v[108:109], v10 offset:32
  ds_read_b64_tr_b16 v[110:111], v10 offset:544
  ds_read_b64_tr_b16 v[112:113], v10 offset:64
  ds_read_b64_tr_b16 v[114:115], v10 offset:576
  ds_read_b64_tr_b16 v[116:117], v10 offset:96
  ds_read_b64_tr_b16 v[118:119], v10 offset:608
  s_waitcnt lgkmcnt(0)
  ds_read_b64_tr_b16 v[120:121], v10 offset:4096
  ds_read_b64_tr_b16 v[122:123], v10 offset:4608
  ds_read_b64_tr_b16 v[124:125], v10 offset:4128
  ds_read_b64_tr_b16 v[126:127], v10 offset:4640
  ds_read_b64_tr_b16 v[128:129], v10 offset:4160
  ds_read_b64_tr_b16 v[130:131], v10 offset:4672
  ds_read_b64_tr_b16 v[132:133], v10 offset:4192
  ds_read_b64_tr_b16 v[134:135], v10 offset:4704
  s_waitcnt lgkmcnt(0)
  ds_read_b64_tr_b16 v[136:137], v10 offset:8192
  ds_read_b64_tr_b16 v[138:139], v10 offset:8704
  ds_read_b64_tr_b16 v[140:141], v10 offset:8224
  ds_read_b64_tr_b16 v[142:143], v10 offset:8736
  ds_read_b64_tr_b16 v[144:145], v10 offset:8256
  ds_read_b64_tr_b16 v[146:147], v10 offset:8768
  ds_read_b64_tr_b16 v[148:149], v10 offset:8288
  ds_read_b64_tr_b16 v[150:151], v10 offset:8800
  s_waitcnt lgkmcnt(0)
  ds_read_b64_tr_b16 v[152:153], v10 offset:12288
  ds_read_b64_tr_b16 v[154:155], v10 offset:12800
  ds_read_b64_tr_b16 v[156:157], v10 offset:12320
  ds_read_b64_tr_b16 v[158:159], v10 offset:12832
  ds_read_b64_tr_b16 v[160:161], v10 offset:12352
  ds_read_b64_tr_b16 v[162:163], v10 offset:12864
  ds_read_b64_tr_b16 v[164:165], v10 offset:12384
  ds_read_b64_tr_b16 v[166:167], v10 offset:12896
  s_waitcnt lgkmcnt(0)
L_G2E:
  s_waitcnt lgkmcnt(0)
  s_barrier
  s_cmp_lg_u32 s24, 8
  s_cbranch_scc1 L_SELS
  v_mov_b32 v16, 0
  v_mov_b32 v17, 0
  v_mov_b32 v18, 0
  v_mov_b32 v19, 0
  v_mov_b32 v20, 0
  v_mov_b32 v21, 0
  v_mov_b32 v22, 0
  v_mov_b32 v23, 0
  v_and_b32 v8, 15, v0
  v_cmp_eq_u32 vcc, 0, v8
  v_mov_b32 v9, 16256
  s_nop 1
  v_cndmask_b32 v16, v16, v9, vcc
  v_cmp_eq_u32 vcc, 1, v8
  v_mov_b32 v9, 1065353216
  s_nop 1
  v_cndmask_b32 v16, v16, v9, vcc
  v_cmp_eq_u32 vcc, 2, v8
  v_mov_b32 v9, 16256
  s_nop 1
  v_cndmask_b32 v17, v17, v9, vcc
  v_cmp_eq_u32 vcc, 3, v8
  v_mov_b32 v9, 1065353216
  s_nop 1
  v_cndmask_b32 v17, v17, v9, vcc
  v_cmp_eq_u32 vcc, 4, v8
  v_mov_b32 v9, 16256
  s_nop 1
  v_cndmask_b32 v18, v18, v9, vcc
  v_cmp_eq_u32 vcc, 5, v8
  v_mov_b32 v9, 1065353216
  s_nop 1
  v_cndmask_b32 v18, v18, v9, vcc
  v_cmp_eq_u32 vcc, 6, v8
  v_mov_b32 v9, 16256
  s_nop 1
  v_cndmask_b32 v19, v19, v9, vcc
  v_cmp_eq_u32 vcc, 7, v8
  v_mov_b32 v9, 1065353216
  s_nop 1
  v_cndmask_b32 v19, v19, v9, vcc
  v_cmp_eq_u32 vcc, 8, v8
  v_mov_b32 v9, 16256
  s_nop 1
  v_cndmask_b32 v20, v20, v9, vcc
  v_cmp_eq_u32 vcc, 9, v8
  v_mov_b32 v9, 1065353216
  s_nop 1
  v_cndmask_b32 v20, v20, v9, vcc
  v_cmp_eq_u32 vcc, 10, v8
  v_mov_b32 v9, 16256
  s_nop 1
  v_cndmask_b32 v21, v21, v9, vcc
  v_cmp_eq_u32 vcc, 11, v8
  v_mov_b32 v9, 1065353216
  s_nop 1
  v_cndmask_b32 v21, v21, v9, vcc
  v_cmp_eq_u32 vcc, 12, v8
  v_mov_b32 v9, 16256
  s_nop 1
  v_cndmask_b32 v22, v22, v9, vcc
  v_cmp_eq_u32 vcc, 13, v8
  v_mov_b32 v9, 1065353216
  s_nop 1
  v_cndmask_b32 v22, v22, v9, vcc
  v_cmp_eq_u32 vcc, 14, v8
  v_mov_b32 v9, 16256
  s_nop 1
  v_cndmask_b32 v23, v23, v9, vcc
  v_cmp_eq_u32 vcc, 15, v8
  v_mov_b32 v9, 1065353216
  s_nop 1
  v_cndmask_b32 v23, v23, v9, vcc
  ds_write_b128 v1, v[16:19] offset:1024
  ds_write_b128 v1, v[20:23] offset:2048
L_SELS:
  v_mov_b32 v8, 0
  v_lshlrev_b32 v9, 2, v0
  ds_write_b32 v9, v8 offset:0
  ds_write_b32 v9, v8 offset:256
  s_waitcnt lgkmcnt(0)
  s_barrier
  s_cmp_ge_u32 s26, 16
  s_cbranch_scc1 L_BULK
  s_cmp_ge_u32 s24, 8
  s_cbranch_scc1 L_CB
L_CA:
  s_setprio 2
  s_mov_b32 s30, 1609728
  v_lshlrev_b32 v8, 2, v0
L_T2FC:
  buffer_load_dword v9, v8, s[4:7], s30 offen offset:0 sc1
  buffer_load_dword v10, v8, s[4:7], s30 offen offset:256 sc1
  buffer_load_dword v11, v8, s[4:7], s30 offen offset:512 sc1
  buffer_load_dword v12, v8, s[4:7], s30 offen offset:768 sc1
  s_waitcnt vmcnt(0)
  v_min3_u32 v9, v9, v10, v11
  v_min_u32 v9, v9, v12
  v_cmp_eq_u32 vcc, 0, v9
  s_cbranch_vccz L_T2KC
  s_add_u32 s67, s67, 1
  s_cmp_lt_u32 s67, 524288
  s_cbranch_scc1 L_T2FC
  s_branch L_END
L_T2KC:
  s_mov_b32 s30, 8404992
  s_mov_b32 s31, 0
  v_mov_b32 v8, 0
  v_mov_b32 v9, 0
L_T2LC:
  buffer_load_dwordx4 v[16:19], v1, s[4:7], s30 offen offset:0 sc1
  buffer_load_dwordx4 v[20:23], v1, s[4:7], s30 offen offset:1024 sc1
  buffer_load_dwordx4 v[24:27], v1, s[4:7], s30 offen offset:2048 sc1
  buffer_load_dwordx4 v[28:31], v1, s[4:7], s30 offen offset:3072 sc1
  s_waitcnt vmcnt(0)
  v_med3_u32 v9, v8, v9, v16
  v_max_u32 v8, v8, v16
  v_med3_u32 v9, v8, v9, v17
  v_max_u32 v8, v8, v17
  v_med3_u32 v9, v8, v9, v18
  v_max_u32 v8, v8, v18
  v_med3_u32 v9, v8, v9, v19
  v_max_u32 v8, v8, v19
  v_med3_u32 v9, v8, v9, v20
  v_max_u32 v8, v8, v20
  v_med3_u32 v9, v8, v9, v21
  v_max_u32 v8, v8, v21
  v_med3_u32 v9, v8, v9, v22
  v_max_u32 v8, v8, v22
  v_med3_u32 v9, v8, v9, v23
  v_max_u32 v8, v8, v23
  v_med3_u32 v9, v8, v9, v24
  v_max_u32 v8, v8, v24
  v_med3_u32 v9, v8, v9, v25
  v_max_u32 v8, v8, v25
  v_med3_u32 v9, v8, v9, v26
  v_max_u32 v8, v8, v26
  v_med3_u32 v9, v8, v9, v27
  v_max_u32 v8, v8, v27
  v_med3_u32 v9, v8, v9, v28
  v_max_u32 v8, v8, v28
  v_med3_u32 v9, v8, v9, v29
  v_max_u32 v8, v8, v29
  v_med3_u32 v9, v8, v9, v30
  v_max_u32 v8, v8, v30
  v_med3_u32 v9, v8, v9, v31
  v_max_u32 v8, v8, v31
  s_add_u32 s30, s30, 4096
  s_add_u32 s31, s31, 1
  s_cmp_lt_u32 s31, 2
  s_cbranch_scc1 L_T2LC
  v_mov_b32 v10, v8
  s_nop 1
  v_max_u32_dpp v10, v10, v10 row_ror:8 row_mask:0xf bank_mask:0xf
  s_nop 1
  v_max_u32_dpp v10, v10, v10 row_ror:4 row_mask:0xf bank_mask:0xf
  s_nop 1
  v_max_u32_dpp v10, v10, v10 row_ror:2 row_mask:0xf bank_mask:0xf
  s_nop 1
  v_max_u32_dpp v10, v10, v10 row_ror:1 row_mask:0xf bank_mask:0xf
  v_mov_b32 v11, v10
  s_nop 1
  v_permlane16_swap_b32 v10, v11
  s_nop 1
  v_max_u32 v10, v10, v11
  v_mov_b32 v11, v10
  s_nop 1
  v_permlane32_swap_b32 v10, v11
  s_nop 1
  v_max_u32 v10, v10, v11
  v_cmp_eq_u32 vcc, v8, v10
  s_nop 1
  v_cndmask_b32 v8, v8, v9, vcc
  s_nop 1
  v_max_u32_dpp v8, v8, v8 row_ror:8 row_mask:0xf bank_mask:0xf
  s_nop 1
  v_max_u32_dpp v8, v8, v8 row_ror:4 row_mask:0xf bank_mask:0xf
  s_nop 1
  v_max_u32_dpp v8, v8, v8 row_ror:2 row_mask:0xf bank_mask:0xf
  s_nop 1
  v_max_u32_dpp v8, v8, v8 row_ror:1 row_mask:0xf bank_mask:0xf
  v_mov_b32 v11, v8
  s_nop 1
  v_permlane16_swap_b32 v8, v11
  s_nop 1
  v_max_u32 v8, v8, v11
  v_mov_b32 v11, v8
  s_nop 1
  v_permlane32_swap_b32 v8, v11
  s_nop 1
  v_max_u32 v8, v8, v11
  v_readfirstlane_b32 s62, v10
  v_readfirstlane_b32 s63, v8
  s_and_b32 s62, s62, 0xffff
  s_sub_u32 s62, 0xffff, s62
  s_and_b32 s62, s62, 2047
  s_and_b32 s63, s63, 0xffff
  s_sub_u32 s63, 0xffff, s63
  s_and_b32 s63, s63, 2047
  v_mov_b32 v8, s62
  v_mov_b32 v9, s63
  v_mov_b32 v10, 1
  v_mov_b32 v11, 1
  v_mov_b32 v5, 192
  ds_write_b128 v5, v[8:11]
  v_and_b32 v6, 7, v0
  v_lshrrev_b32 v7, 4, v0
  v_lshlrev_b32 v16, 11, v6
  v_lshlrev_b32 v17, 4, v7
  v_add_u32 v16, v16, v17
  v_and_b32 v17, 8, v0
  v_lshl_add_u32 v16, v17, 3, v16
  v_lshlrev_b32 v18, 4, v6
  v_and_b32 v17, 1, v7
  v_lshlrev_b32 v17, 3, v17
  v_add_u32 v19, v18, v17
  v_lshrrev_b32 v17, 1, v7
  v_lshlrev_b32 v2, 8, v17
  v_add_u32 v2, v2, v19
  v_and_b32 v17, 0x80, v1
  v_add_u32 v2, v2, v17
  s_lshl_b32 s30, s24, 9
  s_add_u32 s30, s30, 3072
  v_add_u32 v2, s30, v2
  v_lshrrev_b32 v5, 1, v1
  v_and_b32 v17, 0x80, v1
  v_lshlrev_b32 v17, 2, v17
  v_lshlrev_b32 v0, 7, v7
  v_add_u32 v0, v0, v18
  v_add_u32 v0, v0, v17
  s_lshl_b32 s101, s24, 2
  s_add_u32 s101, s101, 80
  v_mov_b32 v3, 0xeeee
  s_mov_b64 exec, s[90:91]
  v_mov_b32 v3, 0x4444
  s_mov_b64 exec, -1
  s_lshl_b32 s78, s25, 16
  s_lshl_b32 s30, s24, 11
  s_add_u32 s78, s78, s30
  s_add_u32 s78, s78, 0
  s_mul_i32 s79, s25, 98304
  s_add_u32 s79, s79, 524288
  s_lshr_b32 s30, s71, 2
  s_mul_i32 s99, s30, 6144
  s_and_b32 s30, s71, 1
  s_lshl_b32 s30, s30, 10
  s_add_u32 s99, s99, s30
  s_bfe_u32 s30, s71, 0x10001
  s_lshl_b32 s30, s30, 7
  s_add_u32 s99, s99, s30
  s_lshl_b32 s30, s24, 9
  s_add_u32 s99, s99, s30
  s_add_u32 s99, s99, 4096
  s_lshr_b32 s30, s71, 2
  s_lshl_b32 s31, s30, 11
  s_add_u32 s98, s99, s31
  s_lshl_b32 s31, s25, 15
  s_add_u32 s98, s98, s31
  s_add_u32 s98, s98, 83886080
  s_lshl_b32 s100, s25, 8
  s_lshl_b32 s30, s71, 4
  s_add_u32 s100, s100, s30
  s_lshl_b32 s30, s24, 2
  s_add_u32 s100, s100, s30
  s_add_u32 s100, s100, 1613832
  s_lshl_b32 s80, s71, 14
  s_add_u32 s80, s80, s69
  s_lshl_b32 s66, s25, 10
  s_add_u32 s80, s80, s66
  s_and_b32 s66, s24, 1
  s_lshl_b32 s66, s66, 9
  s_add_u32 s80, s80, s66
  s_and_b32 s66, s24, 2
  s_lshl_b32 s66, s66, 12
  s_add_u32 s80, s80, s66
  s_lshr_b32 s88, s24, 1
  s_lshl_b32 s88, s88, 12
  s_and_b32 s30, s24, 1
  s_lshl_b32 s30, s30, 3
  s_add_u32 s88, s88, s30
  s_add_u32 s88, s88, 31744
  s_and_b32 s76, s24, 1
  s_lshl_b32 s77, s76, 12
  s_lshl_b32 s76, s76, 11
  s_add_u32 s77, s77, 19456
  s_add_u32 s76, s76, 27648
  s_mov_b32 s12, s34
  s_and_b32 s13, s35, 0xffff
  s_mov_b32 s14, 16384
  s_mov_b32 s15, 0x20000
  s_lshl_b32 s30, s24, 8
  buffer_load_dwordx4 v[8:11], v16, s[12:15], s30 offen offset:0
  buffer_load_dwordx4 v[12:15], v16, s[12:15], s30 offen offset:128
  s_waitcnt vmcnt(0)
  v_min_u32 v8, -2, v8
  v_min_u32 v9, -2, v9
  v_min_u32 v10, -2, v10
  v_min_u32 v11, -2, v11
  v_min_u32 v12, -2, v12
  v_min_u32 v13, -2, v13
  v_min_u32 v14, -2, v14
  v_min_u32 v15, -2, v15
  s_mov_b32 s28, 0
  s_add_u32 s29, s28, 1
  v_mov_b32 v4, s29
  s_and_b32 s30, s28, 3
  s_lshl_b32 s31, s30, 14
  s_add_u32 s84, s78, s31
  s_mul_i32 s31, s30, 24576
  s_add_u32 s31, s31, s79
  s_add_u32 s89, s31, s99
  s_lshr_b32 s65, s24, 1
  s_mul_i32 s65, s65, 6144
  s_add_u32 s85, s31, s65
  s_and_b32 s65, s24, 1
  s_lshl_b32 s65, s65, 10
  s_add_u32 s85, s85, s65
  s_add_u32 s85, s85, 4096
  s_lshl_b32 s31, s30, 18
  s_add_u32 s86, s80, s31
  s_xor_b32 s31, s31, 0x80000
  s_add_u32 s87, s80, s31
  v_mov_b32 v16, 0
  v_mov_b32 v17, 0
  v_mov_b32 v18, 0
  v_mov_b32 v19, 0
  v_mov_b32 v20, 0
  v_mov_b32 v21, 0
  v_mov_b32 v22, 0
  v_mov_b32 v23, 0
  v_mov_b32 v24, 0
  v_mov_b32 v25, 0
  v_mov_b32 v26, 0
  v_mov_b32 v27, 0
  v_mov_b32 v28, 0
  v_mov_b32 v29, 0
  v_mov_b32 v30, 0
  v_mov_b32 v31, 0
  v_mov_b32 v32, 0
  v_mov_b32 v33, 0
  v_mov_b32 v34, 0
  v_mov_b32 v35, 0
  v_mov_b32 v36, 0
  v_mov_b32 v37, 0
  v_mov_b32 v38, 0
  v_mov_b32 v39, 0
  s_barrier
  s_branch L_CW0
L_CA_LOOP:
  s_add_u32 s29, s28, 1
  v_mov_b32 v4, s29
  s_and_b32 s30, s28, 3
  s_lshl_b32 s31, s30, 14
  s_add_u32 s84, s78, s31
  s_mul_i32 s31, s30, 24576
  s_add_u32 s31, s31, s79
  s_add_u32 s89, s31, s99
  s_lshr_b32 s65, s24, 1
  s_mul_i32 s65, s65, 6144
  s_add_u32 s85, s31, s65
  s_and_b32 s65, s24, 1
  s_lshl_b32 s65, s65, 10
  s_add_u32 s85, s85, s65
  s_add_u32 s85, s85, 4096
  s_lshl_b32 s31, s30, 18
  s_add_u32 s86, s80, s31
  s_xor_b32 s31, s31, 0x80000
  s_add_u32 s87, s80, s31
  v_mov_b32 v16, 0
  v_mov_b32 v17, 0
  v_mov_b32 v18, 0
  v_mov_b32 v19, 0
  v_mov_b32 v20, 0
  v_mov_b32 v21, 0
  v_mov_b32 v22, 0
  v_mov_b32 v23, 0
  v_mov_b32 v24, 0
  v_mov_b32 v25, 0
  v_mov_b32 v26, 0
  v_mov_b32 v27, 0
  v_mov_b32 v28, 0
  v_mov_b32 v29, 0
  v_mov_b32 v30, 0
  v_mov_b32 v31, 0
  v_mov_b32 v32, 0
  v_mov_b32 v33, 0
  v_mov_b32 v34, 0
  v_mov_b32 v35, 0
  v_mov_b32 v36, 0
  v_mov_b32 v37, 0
  v_mov_b32 v38, 0
  v_mov_b32 v39, 0
  s_waitcnt vmcnt(0)
  s_barrier
  s_sleep 1
  buffer_load_dwordx4 v[8:11], v0, s[4:7], s84 offen offset:0 sc1
  buffer_load_dwordx4 v[12:15], v0, s[4:7], s84 offen offset:1024 sc1
L_CW0:
  s_waitcnt vmcnt(1)
  v_max3_u32 v6, v8, v9, v10
  v_max_u32 v6, v6, v11
  v_cmp_eq_u32 vcc, -1, v6
  s_cbranch_vccnz L_CR0
  v_smfmac_f32_16x16x64_bf16 v[16:19], v[8:11], v[40:47], v3
  v_smfmac_f32_16x16x64_bf16 v[20:23], v[8:11], v[56:63], v3
  v_smfmac_f32_16x16x64_bf16 v[24:27], v[8:11], v[72:79], v3
  v_smfmac_f32_16x16x64_bf16 v[28:31], v[8:11], v[88:95], v3
  v_smfmac_f32_16x16x64_bf16 v[32:35], v[8:11], v[104:111], v3
  v_smfmac_f32_16x16x64_bf16 v[36:39], v[8:11], v[120:127], v3
L_CW1:
  s_waitcnt vmcnt(0)
  v_max3_u32 v6, v12, v13, v14
  v_max_u32 v6, v6, v15
  v_cmp_eq_u32 vcc, -1, v6
  s_cbranch_vccnz L_CR1
  v_smfmac_f32_16x16x64_bf16 v[16:19], v[12:15], v[48:55], v3
  v_smfmac_f32_16x16x64_bf16 v[20:23], v[12:15], v[64:71], v3
  v_smfmac_f32_16x16x64_bf16 v[24:27], v[12:15], v[80:87], v3
  v_smfmac_f32_16x16x64_bf16 v[28:31], v[12:15], v[96:103], v3
  v_smfmac_f32_16x16x64_bf16 v[32:35], v[12:15], v[112:119], v3
  v_smfmac_f32_16x16x64_bf16 v[36:39], v[12:15], v[128:135], v3
  ds_read_b128 v[8:11], v1 offset:1024
  s_nop 1
  v_cvt_pk_bf16_f32 v16, v16, v17
  v_cvt_pk_bf16_f32 v17, v18, v19
  ds_write_b64 v2, v[16:17] offset:0
  v_cvt_pk_bf16_f32 v20, v20, v21
  v_cvt_pk_bf16_f32 v21, v22, v23
  ds_write_b64 v2, v[20:21] offset:4096
  v_cvt_pk_bf16_f32 v24, v24, v25
  v_cvt_pk_bf16_f32 v25, v26, v27
  ds_write_b64 v2, v[24:25] offset:8192
  v_cvt_pk_bf16_f32 v28, v28, v29
  v_cvt_pk_bf16_f32 v29, v30, v31
  ds_write_b64 v2, v[28:29] offset:12288
  v_cvt_pk_bf16_f32 v32, v32, v33
  v_cvt_pk_bf16_f32 v33, v34, v35
  ds_write_b64 v2, v[32:33] offset:16384
  v_cvt_pk_bf16_f32 v36, v36, v37
  v_cvt_pk_bf16_f32 v37, v38, v39
  ds_write_b64 v2, v[36:37] offset:20480
  v_add_u32 v7, s77, v1
  s_waitcnt lgkmcnt(0)
  s_barrier
  s_cmp_ge_u32 s24, 2
  s_cbranch_scc1 L_CA_NV
  ds_read_b128 v[16:19], v7 offset:0
  ds_read_b128 v[20:23], v7 offset:1024
  ds_read_b128 v[24:27], v7 offset:2048
  ds_read_b128 v[28:31], v7 offset:3072
  v_and_b32 v38, 0x70, v1
  v_bfe_u32 v6, v1, 9, 1
  v_lshl_add_u32 v38, v6, 8, v38
  v_bfe_u32 v6, v1, 8, 1
  v_lshl_add_u32 v38, v6, 3, v38
  s_waitcnt lgkmcnt(3)
  v_mfma_f32_16x16x32_bf16 v[32:35], v[16:19], v[8:11], 0
  s_waitcnt lgkmcnt(2)
  v_mfma_f32_16x16x32_bf16 v[32:35], v[20:23], v[8:11], v[32:35]
  s_waitcnt lgkmcnt(1)
  v_mfma_f32_16x16x32_bf16 v[32:35], v[24:27], v[8:11], v[32:35]
  s_waitcnt lgkmcnt(0)
  v_mfma_f32_16x16x32_bf16 v[32:35], v[28:31], v[8:11], v[32:35]
  s_mov_b64 exec, s[90:91]
  s_nop 6
  v_cvt_pk_bf16_f32 v36, v32, v33
  v_cvt_pk_bf16_f32 v37, v34, v35
  v_min_u32 v36, -2, v36
  v_min_u32 v37, -2, v37
  s_cmp_eq_u32 s27, 0
  s_cbranch_scc0 LS_1
  buffer_store_dwordx2 v[36:37], v38, s[4:7], s89 offen
LD_2:
  s_mov_b64 exec, -1
  s_sleep 5
  s_branch L_CA_VG
L_CA_NV:
  s_sleep 8
L_CA_VG:
  s_cmp_eq_u32 s28, 63
  s_cbranch_scc1 L_CA_SK
  buffer_load_dwordx4 v[8:11], v1, s[4:7], s85 offen sc1
  v_mov_b32 v16, 0
  v_mov_b32 v17, 0
  v_mov_b32 v18, 0
  v_mov_b32 v19, 0
  v_mov_b32 v20, 0
  v_mov_b32 v21, 0
  v_mov_b32 v22, 0
  v_mov_b32 v23, 0
  v_mov_b32 v24, 0
  v_mov_b32 v25, 0
  v_mov_b32 v26, 0
  v_mov_b32 v27, 0
  v_mov_b32 v28, 0
  v_mov_b32 v29, 0
  v_mov_b32 v30, 0
  v_mov_b32 v31, 0
  v_add_u32 v7, s88, v1
  v_mov_b32 v12, s101
L_VW0:
  s_waitcnt vmcnt(0)
  v_max3_u32 v6, v8, v9, v10
  v_max_u32 v6, v6, v11
  v_cmp_eq_u32 vcc, -1, v6
  s_cbranch_vccnz L_VR0
  v_smfmac_f32_16x16x64_bf16 v[16:19], v[8:11], v[136:143], v3
  v_smfmac_f32_16x16x64_bf16 v[20:23], v[8:11], v[144:151], v3
  v_smfmac_f32_16x16x64_bf16 v[24:27], v[8:11], v[152:159], v3
  v_smfmac_f32_16x16x64_bf16 v[28:31], v[8:11], v[160:167], v3
  s_nop 4
  v_cvt_pk_bf16_f32 v16, v16, v17
  v_cvt_pk_bf16_f32 v17, v18, v19
  ds_write_b64 v7, v[16:17] offset:0
  v_cvt_pk_bf16_f32 v20, v20, v21
  v_cvt_pk_bf16_f32 v21, v22, v23
  ds_write_b64 v7, v[20:21] offset:1024
  v_cvt_pk_bf16_f32 v24, v24, v25
  v_cvt_pk_bf16_f32 v25, v26, v27
  ds_write_b64 v7, v[24:25] offset:2048
  v_cvt_pk_bf16_f32 v28, v28, v29
  v_cvt_pk_bf16_f32 v29, v30, v31
  ds_write_b64 v7, v[28:29] offset:3072
  ds_write_b32 v12, v4
L_CA_SK:
  s_cmp_ge_u32 s24, 2
  s_cbranch_scc1 L_CA_NP
  v_mov_b32 v6, -1
  v_mov_b32 v7, -1
  s_add_u32 s30, s28, 3
  s_and_b32 s30, s30, 3
  s_mul_i32 s30, s30, 24576
  s_add_u32 s30, s30, s79
  s_add_u32 s30, s30, s99
  s_mov_b64 exec, s[90:91]
  s_and_b32 s31, s28, s20
  s_lshl_b32 s31, s31, 18
  s_add_u32 s31, s31, s98
  s_cmp_eq_u32 s27, 0
  s_cbranch_scc0 LS_3
  buffer_store_dwordx2 v[36:37], v38, s[4:7], s31 offen
  buffer_store_dwordx2 v[6:7], v38, s[4:7], s30 offen
LD_4:
  s_mov_b64 exec, -1
L_CA_NP:
  s_cmp_eq_u32 s28, 63
  s_cbranch_scc1 L_CA_CP
  ds_read_b128 v[8:11], v1 offset:1024
  ds_read_b128 v[12:15], v1 offset:2048
  v_add_u32 v7, s76, v1
  s_waitcnt lgkmcnt(0)
  s_barrier
  s_cmp_ge_u32 s24, 4
  s_cbranch_scc1 L_CA_NB
  ds_read_b128 v[16:19], v7
  ds_read_b128 v[20:23], v7 offset:1024
  s_waitcnt lgkmcnt(1)
  v_mfma_f32_16x16x32_bf16 v[24:27], v[8:11], v[16:19], 0
  s_waitcnt lgkmcnt(0)
  v_mfma_f32_16x16x32_bf16 v[24:27], v[12:15], v[20:23], v[24:27]
  s_nop 7
  v_cvt_pk_bf16_f32 v28, v24, v25
  v_cvt_pk_bf16_f32 v29, v26, v27
  v_min_u32 v28, -2, v28
  v_min_u32 v29, -2, v29
  buffer_store_dwordx2 v[28:29], v5, s[4:7], s86 offen sc1
L_CA_NB:
  s_barrier
  s_cmp_lt_u32 s24, 4
  s_cbranch_scc1 L_CA_NQ
  v_mov_b32 v6, -1
  v_mov_b32 v7, -1
  buffer_store_dwordx2 v[6:7], v5, s[4:7], s87 offen sc1
L_CA_NQ:
L_CA_CP:
  s_cmp_ge_u32 s24, 2
  s_cbranch_scc1 L_CA_NF
  s_waitcnt vmcnt(0)
  s_mov_b64 exec, 1
  v_mov_b32 v6, 0
  s_cmp_eq_u32 s27, 0
  s_cbranch_scc0 LS_5
  buffer_store_dword v4, v6, s[4:7], s100 offen
LD_6:
  s_mov_b64 exec, -1
L_CA_NF:
  s_cmp_eq_u32 s28, 63
  s_cbranch_scc1 L_CA_DONE
  s_add_u32 s28, s28, 1
  s_branch L_CA_LOOP
L_CA_DONE:
  v_lshrrev_b32 v0, 4, v1
  s_lshl_b32 s30, s24, 2
  s_add_u32 s30, s30, 0
  v_mov_b32 v3, s30
  s_lshr_b32 s88, s24, 2
  s_lshl_b32 s66, s25, 4
  s_add_u32 s66, s66, s71
  s_min_u32 s89, s66, 111
  s_lshr_b32 s30, s62, 4
  s_lshl_b32 s30, s30, 15
  s_and_b32 s65, s62, 15
  s_lshl_b32 s65, s65, 4
  s_add_u32 s30, s30, s65
  s_lshr_b32 s31, s63, 4
  s_lshl_b32 s31, s31, 15
  s_and_b32 s65, s63, 15
  s_lshl_b32 s65, s65, 4
  s_add_u32 s31, s31, s65
  v_and_b32 v5, 1, v0
  v_cmp_eq_u32 vcc, 1, v5
  v_mov_b32 v5, s30
  v_mov_b32 v6, s31
  v_cndmask_b32 v5, v5, v6, vcc
  v_lshrrev_b32 v6, 4, v0
  v_lshl_add_u32 v5, v6, 8, v5
  s_lshl_b32 s30, s24, 12
  s_add_u32 s30, s30, 25165824
  buffer_load_dwordx4 v[16:19], v5, s[4:7], s30 offen offset:0
  buffer_load_dwordx4 v[20:23], v5, s[4:7], s30 offen offset:1024
  buffer_load_dwordx4 v[24:27], v5, s[4:7], s30 offen offset:2048
  buffer_load_dwordx4 v[28:31], v5, s[4:7], s30 offen offset:3072
  v_lshrrev_b32 v5, 2, v0
  v_mul_u32_u24 v5, 7168, v5
  v_and_b32 v6, 3, v0
  v_lshl_add_u32 v5, v6, 4, v5
  s_mul_i32 s30, s24, 917504
  s_lshl_b32 s31, s89, 6
  s_add_u32 s30, s30, s31
  s_lshl_b32 s65, s24, 14
  s_mov_b32 s12, s50
  s_and_b32 s13, s51, 0xffff
  s_mov_b32 s14, 7340032
  s_mov_b32 s15, 0x20000
  s_add_u32 s31, s30, 0
  s_add_u32 m0, s65, 27648
  s_nop 0
  buffer_load_dwordx4 v5, s[12:15], s31 offen nt lds
  s_add_u32 s31, s30, 114688
  s_add_u32 m0, s65, 28672
  s_nop 0
  buffer_load_dwordx4 v5, s[12:15], s31 offen nt lds
  s_add_u32 s31, s30, 229376
  s_add_u32 m0, s65, 29696
  s_nop 0
  buffer_load_dwordx4 v5, s[12:15], s31 offen nt lds
  s_add_u32 s31, s30, 344064
  s_add_u32 m0, s65, 30720
  s_nop 0
  buffer_load_dwordx4 v5, s[12:15], s31 offen nt lds
  s_add_u32 s31, s30, 458752
  s_add_u32 m0, s65, 31744
  s_nop 0
  buffer_load_dwordx4 v5, s[12:15], s31 offen nt lds
  s_add_u32 s31, s30, 573440
  s_add_u32 m0, s65, 32768
  s_nop 0
  buffer_load_dwordx4 v5, s[12:15], s31 offen nt lds
  s_add_u32 s31, s30, 688128
  s_add_u32 m0, s65, 33792
  s_nop 0
  buffer_load_dwordx4 v5, s[12:15], s31 offen nt lds
  s_add_u32 s31, s30, 802816
  s_add_u32 m0, s65, 34816
  s_nop 0
  buffer_load_dwordx4 v5, s[12:15], s31 offen nt lds
  s_mov_b32 s12, s52
  s_and_b32 s13, s53, 0xffff
  s_mov_b32 s14, 7340032
  s_mov_b32 s15, 0x20000
  s_add_u32 s31, s30, 0
  s_add_u32 m0, s65, 35840
  s_nop 0
  buffer_load_dwordx4 v5, s[12:15], s31 offen nt lds
  s_add_u32 s31, s30, 114688
  s_add_u32 m0, s65, 36864
  s_nop 0
  buffer_load_dwordx4 v5, s[12:15], s31 offen nt lds
  s_add_u32 s31, s30, 229376
  s_add_u32 m0, s65, 37888
  s_nop 0
  buffer_load_dwordx4 v5, s[12:15], s31 offen nt lds
  s_add_u32 s31, s30, 344064
  s_add_u32 m0, s65, 38912
  s_nop 0
  buffer_load_dwordx4 v5, s[12:15], s31 offen nt lds
  s_add_u32 s31, s30, 458752
  s_add_u32 m0, s65, 39936
  s_nop 0
  buffer_load_dwordx4 v5, s[12:15], s31 offen nt lds
  s_add_u32 s31, s30, 573440
  s_add_u32 m0, s65, 40960
  s_nop 0
  buffer_load_dwordx4 v5, s[12:15], s31 offen nt lds
  s_add_u32 s31, s30, 688128
  s_add_u32 m0, s65, 41984
  s_nop 0
  buffer_load_dwordx4 v5, s[12:15], s31 offen nt lds
  s_add_u32 s31, s30, 802816
  s_add_u32 m0, s65, 43008
  s_nop 0
  buffer_load_dwordx4 v5, s[12:15], s31 offen nt lds
  v_lshrrev_b32 v6, 4, v0
  v_lshlrev_b32 v5, 3, v6
  v_bfe_u32 v8, v0, 2, 2
  v_add_u32 v5, v5, v8
  v_lshlrev_b32 v7, 8, v5
  v_lshlrev_b32 v5, 6, v5
  v_and_b32 v8, 3, v0
  v_lshl_add_u32 v5, v8, 3, v5
  v_lshl_add_u32 v7, v8, 3, v7
  s_lshl_b32 s30, s24, 14
  s_add_u32 s30, s30, 27648
  v_add_u32 v5, s30, v5
  v_and_b32 v8, 1, v0
  v_lshl_add_u32 v8, v6, 1, v8
  v_lshlrev_b32 v8, 4, v8
  s_lshl_b32 s30, s24, 9
  s_add_u32 s30, s30, 158720
  v_add_u32 v8, s30, v8
  s_waitcnt vmcnt(0)
  ds_read_b64_tr_b16 v[40:41], v5 offset:0
  ds_read_b64_tr_b16 v[42:43], v5 offset:256
  ds_read_b64_tr_b16 v[44:45], v5 offset:2048
  ds_read_b64_tr_b16 v[46:47], v5 offset:2304
  ds_read_b64_tr_b16 v[48:49], v5 offset:4096
  ds_read_b64_tr_b16 v[50:51], v5 offset:4352
  ds_read_b64_tr_b16 v[52:53], v5 offset:6144
  ds_read_b64_tr_b16 v[54:55], v5 offset:6400
  ds_read_b64_tr_b16 v[56:57], v5 offset:32
  ds_read_b64_tr_b16 v[58:59], v5 offset:288
  ds_read_b64_tr_b16 v[60:61], v5 offset:2080
  ds_read_b64_tr_b16 v[62:63], v5 offset:2336
  ds_read_b64_tr_b16 v[64:65], v5 offset:4128
  ds_read_b64_tr_b16 v[66:67], v5 offset:4384
  ds_read_b64_tr_b16 v[68:69], v5 offset:6176
  ds_read_b64_tr_b16 v[70:71], v5 offset:6432
  s_waitcnt lgkmcnt(0)
  ds_read_b64_tr_b16 v[72:73], v5 offset:8192
  ds_read_b64_tr_b16 v[74:75], v5 offset:8448
  ds_read_b64_tr_b16 v[76:77], v5 offset:10240
  ds_read_b64_tr_b16 v[78:79], v5 offset:10496
  ds_read_b64_tr_b16 v[80:81], v5 offset:12288
  ds_read_b64_tr_b16 v[82:83], v5 offset:12544
  ds_read_b64_tr_b16 v[84:85], v5 offset:14336
  ds_read_b64_tr_b16 v[86:87], v5 offset:14592
  ds_read_b64_tr_b16 v[88:89], v5 offset:8224
  ds_read_b64_tr_b16 v[90:91], v5 offset:8480
  ds_read_b64_tr_b16 v[92:93], v5 offset:10272
  ds_read_b64_tr_b16 v[94:95], v5 offset:10528
  ds_read_b64_tr_b16 v[96:97], v5 offset:12320
  ds_read_b64_tr_b16 v[98:99], v5 offset:12576
  ds_read_b64_tr_b16 v[100:101], v5 offset:14368
  ds_read_b64_tr_b16 v[102:103], v5 offset:14624
  s_waitcnt lgkmcnt(0)
  v_mfma_f32_16x16x32_bf16 v[104:107], v[40:43], v[16:19], 0
  v_mfma_f32_16x16x32_bf16 v[104:107], v[44:47], v[20:23], v[104:107]
  v_mfma_f32_16x16x32_bf16 v[104:107], v[48:51], v[24:27], v[104:107]
  v_mfma_f32_16x16x32_bf16 v[104:107], v[52:55], v[28:31], v[104:107]
  v_mfma_f32_16x16x32_bf16 v[108:111], v[56:59], v[16:19], 0
  v_mfma_f32_16x16x32_bf16 v[108:111], v[60:63], v[20:23], v[108:111]
  v_mfma_f32_16x16x32_bf16 v[108:111], v[64:67], v[24:27], v[108:111]
  v_mfma_f32_16x16x32_bf16 v[108:111], v[68:71], v[28:31], v[108:111]
  v_mfma_f32_16x16x32_bf16 v[112:115], v[72:75], v[16:19], 0
  v_mfma_f32_16x16x32_bf16 v[112:115], v[76:79], v[20:23], v[112:115]
  v_mfma_f32_16x16x32_bf16 v[112:115], v[80:83], v[24:27], v[112:115]
  v_mfma_f32_16x16x32_bf16 v[112:115], v[84:87], v[28:31], v[112:115]
  v_mfma_f32_16x16x32_bf16 v[116:119], v[88:91], v[16:19], 0
  v_mfma_f32_16x16x32_bf16 v[116:119], v[92:95], v[20:23], v[116:119]
  v_mfma_f32_16x16x32_bf16 v[116:119], v[96:99], v[24:27], v[116:119]
  v_mfma_f32_16x16x32_bf16 v[116:119], v[100:103], v[28:31], v[116:119]
  s_nop 7
  s_mov_b32 exec_lo, 0x00030003
  s_mov_b32 exec_hi, 0x00030003
  ds_write_b128 v8, v[104:107] offset:0
  ds_write_b128 v8, v[108:111] offset:128
  ds_write_b128 v8, v[112:115] offset:256
  ds_write_b128 v8, v[116:119] offset:384
  s_mov_b64 exec, -1
  s_waitcnt lgkmcnt(0)
  v_mov_b32 v8, 1
  ds_write_b32 v3, v8 offset:160
  v_mov_b32 v9, 160
L_MQ1:
  ds_read_b128 v[16:19], v9
  ds_read_b128 v[20:23], v9 offset:16
  s_waitcnt lgkmcnt(0)
  v_min3_u32 v10, v16, v17, v18
  v_min3_u32 v10, v10, v19, v20
  v_min3_u32 v10, v10, v21, v22
  v_min_u32 v10, v10, v23
  v_cmp_gt_u32 vcc, 1, v10
  s_cbranch_vccz L_MQ1K
  s_add_u32 s67, s67, 1
  s_cmp_lt_u32 s67, 524288
  s_cbranch_scc1 L_MQ1
  s_branch L_END
L_MQ1K:
  s_mov_b32 s12, s54
  s_and_b32 s13, s55, 0xffff
  s_mov_b32 s14, 7340032
  s_mov_b32 s15, 0x20000
  v_lshrrev_b32 v5, 4, v0
  v_lshlrev_b32 v5, 11, v5
  v_and_b32 v6, 15, v0
  v_lshl_add_u32 v5, v6, 4, v5
  s_mul_i32 s30, s71, 458752
  s_mul_i32 s31, s24, 57344
  s_add_u32 s30, s30, s31
  s_lshl_b32 s31, s25, 8
  s_add_u32 s30, s30, s31
  s_mul_i32 s65, s24, 7168
  s_cmp_eq_u32 s24, 0
  s_cbranch_scc1 L_MQ2
  s_add_u32 s31, s30, 0
  s_add_u32 m0, s65, 27648
  s_nop 0
  buffer_load_dwordx4 v5, s[12:15], s31 offen nt lds
  s_add_u32 s31, s30, 8192
  s_add_u32 m0, s65, 28672
  s_nop 0
  buffer_load_dwordx4 v5, s[12:15], s31 offen nt lds
  s_add_u32 s31, s30, 16384
  s_add_u32 m0, s65, 29696
  s_nop 0
  buffer_load_dwordx4 v5, s[12:15], s31 offen nt lds
  s_add_u32 s31, s30, 24576
  s_add_u32 m0, s65, 30720
  s_nop 0
  buffer_load_dwordx4 v5, s[12:15], s31 offen nt lds
  s_add_u32 s31, s30, 32768
  s_add_u32 m0, s65, 31744
  s_nop 0
  buffer_load_dwordx4 v5, s[12:15], s31 offen nt lds
  s_add_u32 s31, s30, 40960
  s_add_u32 m0, s65, 32768
  s_nop 0
  buffer_load_dwordx4 v5, s[12:15], s31 offen nt lds
  s_add_u32 s31, s30, 49152
  s_add_u32 m0, s65, 33792
  s_nop 0
  buffer_load_dwordx4 v5, s[12:15], s31 offen nt lds
  s_branch L_MQ3
L_MQ2:
  s_cmp_ge_u32 s66, 112
  s_cbranch_scc1 L_MQ2b
  v_and_b32 v24, 15, v0
  v_lshlrev_b32 v24, 4, v24
  v_add_u32 v24, 158720, v24
  ds_read_b128 v[40:43], v24 offset:0
  ds_read_b128 v[44:47], v24 offset:256
  ds_read_b128 v[48:51], v24 offset:512
  ds_read_b128 v[52:55], v24 offset:768
  ds_read_b128 v[56:59], v24 offset:1024
  ds_read_b128 v[60:63], v24 offset:1280
  ds_read_b128 v[64:67], v24 offset:1536
  ds_read_b128 v[68:71], v24 offset:1792
  ds_read_b128 v[72:75], v24 offset:2048
  ds_read_b128 v[76:79], v24 offset:2304
  ds_read_b128 v[80:83], v24 offset:2560
  ds_read_b128 v[84:87], v24 offset:2816
  ds_read_b128 v[88:91], v24 offset:3072
  ds_read_b128 v[92:95], v24 offset:3328
  ds_read_b128 v[96:99], v24 offset:3584
  ds_read_b128 v[100:103], v24 offset:3840
  s_waitcnt lgkmcnt(0)
  v_pk_add_f32 v[40:41], v[40:41], v[48:49]
  v_pk_add_f32 v[42:43], v[42:43], v[50:51]
  v_pk_add_f32 v[44:45], v[44:45], v[52:53]
  v_pk_add_f32 v[46:47], v[46:47], v[54:55]
  v_pk_add_f32 v[40:41], v[40:41], v[56:57]
  v_pk_add_f32 v[42:43], v[42:43], v[58:59]
  v_pk_add_f32 v[44:45], v[44:45], v[60:61]
  v_pk_add_f32 v[46:47], v[46:47], v[62:63]
  v_pk_add_f32 v[40:41], v[40:41], v[64:65]
  v_pk_add_f32 v[42:43], v[42:43], v[66:67]
  v_pk_add_f32 v[44:45], v[44:45], v[68:69]
  v_pk_add_f32 v[46:47], v[46:47], v[70:71]
  v_pk_add_f32 v[40:41], v[40:41], v[72:73]
  v_pk_add_f32 v[42:43], v[42:43], v[74:75]
  v_pk_add_f32 v[44:45], v[44:45], v[76:77]
  v_pk_add_f32 v[46:47], v[46:47], v[78:79]
  v_pk_add_f32 v[40:41], v[40:41], v[80:81]
  v_pk_add_f32 v[42:43], v[42:43], v[82:83]
  v_pk_add_f32 v[44:45], v[44:45], v[84:85]
  v_pk_add_f32 v[46:47], v[46:47], v[86:87]
  v_pk_add_f32 v[40:41], v[40:41], v[88:89]
  v_pk_add_f32 v[42:43], v[42:43], v[90:91]
  v_pk_add_f32 v[44:45], v[44:45], v[92:93]
  v_pk_add_f32 v[46:47], v[46:47], v[94:95]
  v_pk_add_f32 v[40:41], v[40:41], v[96:97]
  v_pk_add_f32 v[42:43], v[42:43], v[98:99]
  v_pk_add_f32 v[44:45], v[44:45], v[100:101]
  v_pk_add_f32 v[46:47], v[46:47], v[102:103]
  v_cvt_pk_bf16_f32 v16, v40, v41
  v_cvt_pk_bf16_f32 v17, v42, v43
  v_lshlrev_b32 v40, 16, v16
  v_and_b32 v41, 0xffff0000, v16
  v_lshlrev_b32 v42, 16, v17
  v_and_b32 v43, 0xffff0000, v17
  v_cvt_pk_bf16_f32 v16, v44, v45
  v_cvt_pk_bf16_f32 v17, v46, v47
  v_lshlrev_b32 v44, 16, v16
  v_and_b32 v45, 0xffff0000, v16
  v_lshlrev_b32 v46, 16, v17
  v_and_b32 v47, 0xffff0000, v17
  v_mul_f32 v16, 0xbfb8aa3b, v40
  v_exp_f32 v16, v16
  s_nop 0
  v_add_f32 v16, 1.0, v16
  v_rcp_f32 v16, v16
  s_nop 0
  v_mul_f32 v40, v40, v16
  v_mul_f32 v17, 0xbfb8aa3b, v41
  v_exp_f32 v17, v17
  s_nop 0
  v_add_f32 v17, 1.0, v17
  v_rcp_f32 v17, v17
  s_nop 0
  v_mul_f32 v41, v41, v17
  v_mul_f32 v18, 0xbfb8aa3b, v42
  v_exp_f32 v18, v18
  s_nop 0
  v_add_f32 v18, 1.0, v18
  v_rcp_f32 v18, v18
  s_nop 0
  v_mul_f32 v42, v42, v18
  v_mul_f32 v19, 0xbfb8aa3b, v43
  v_exp_f32 v19, v19
  s_nop 0
  v_add_f32 v19, 1.0, v19
  v_rcp_f32 v19, v19
  s_nop 0
  v_mul_f32 v43, v43, v19
  v_cvt_pk_bf16_f32 v16, v40, v41
  v_cvt_pk_bf16_f32 v17, v42, v43
  v_lshlrev_b32 v40, 16, v16
  v_and_b32 v41, 0xffff0000, v16
  v_lshlrev_b32 v42, 16, v17
  v_and_b32 v43, 0xffff0000, v17
  v_mul_f32 v40, v40, v44
  v_mul_f32 v41, v41, v45
  v_mul_f32 v42, v42, v46
  v_mul_f32 v43, v43, v47
  v_cvt_pk_bf16_f32 v16, v40, v41
  v_cvt_pk_bf16_f32 v17, v42, v43
  v_and_b32 v24, 1, v0
  v_lshlrev_b32 v24, 6, v24
  v_bfe_u32 v6, v0, 1, 3
  v_lshl_add_u32 v24, v6, 3, v24
  s_lshl_b32 s31, s66, 7
  s_add_u32 s31, s31, 8454144
  s_mov_b64 exec, 0xffff
  buffer_store_dwordx2 v[16:17], v24, s[4:7], s31 offen sc1
  s_waitcnt vmcnt(0)
  s_lshl_b32 s31, s66, 3
  s_add_u32 s31, s31, 1610752
  s_mov_b64 exec, 1
  v_mov_b32 v16, 1
  v_mov_b32 v17, 1
  v_mov_b32 v24, 0
  buffer_store_dwordx2 v[16:17], v24, s[4:7], s31 offen sc1
  s_mov_b64 exec, -1
L_MQ2b:
  s_add_u32 s31, s30, 0
  s_add_u32 m0, s65, 27648
  s_nop 0
  buffer_load_dwordx4 v5, s[12:15], s31 offen nt lds
  s_add_u32 s31, s30, 8192
  s_add_u32 m0, s65, 28672
  s_nop 0
  buffer_load_dwordx4 v5, s[12:15], s31 offen nt lds
  s_add_u32 s31, s30, 16384
  s_add_u32 m0, s65, 29696
  s_nop 0
  buffer_load_dwordx4 v5, s[12:15], s31 offen nt lds
  s_add_u32 s31, s30, 24576
  s_add_u32 m0, s65, 30720
  s_nop 0
  buffer_load_dwordx4 v5, s[12:15], s31 offen nt lds
  s_add_u32 s31, s30, 32768
  s_add_u32 m0, s65, 31744
  s_nop 0
  buffer_load_dwordx4 v5, s[12:15], s31 offen nt lds
  s_add_u32 s31, s30, 40960
  s_add_u32 m0, s65, 32768
  s_nop 0
  buffer_load_dwordx4 v5, s[12:15], s31 offen nt lds
  s_add_u32 s31, s30, 49152
  s_add_u32 m0, s65, 33792
  s_nop 0
  buffer_load_dwordx4 v5, s[12:15], s31 offen nt lds
L_MQ3:
  s_waitcnt vmcnt(0)
  v_mov_b32 v8, 2
  ds_write_b32 v3, v8 offset:160
  v_mov_b32 v9, 160
L_MQ4:
  ds_read_b128 v[16:19], v9
  ds_read_b128 v[20:23], v9 offset:16
  s_waitcnt lgkmcnt(0)
  v_min3_u32 v10, v16, v17, v18
  v_min3_u32 v10, v10, v19, v20
  v_min3_u32 v10, v10, v21, v22
  v_min_u32 v10, v10, v23
  v_cmp_gt_u32 vcc, 2, v10
  s_cbranch_vccz L_MQ4K
  s_add_u32 s67, s67, 1
  s_cmp_lt_u32 s67, 524288
  s_cbranch_scc1 L_MQ4
  s_branch L_END
L_MQ4K:
  s_lshl_b32 s30, s24, 5
  s_add_u32 s30, s30, 27648
  v_add_u32 v7, s30, v7
  ds_read_b64_tr_b16 v[40:41], v7 offset:0
  ds_read_b64_tr_b16 v[42:43], v7 offset:1024
  ds_read_b64_tr_b16 v[44:45], v7 offset:8192
  ds_read_b64_tr_b16 v[46:47], v7 offset:9216
  ds_read_b64_tr_b16 v[48:49], v7 offset:16384
  ds_read_b64_tr_b16 v[50:51], v7 offset:17408
  ds_read_b64_tr_b16 v[52:53], v7 offset:24576
  ds_read_b64_tr_b16 v[54:55], v7 offset:25600
  ds_read_b64_tr_b16 v[56:57], v7 offset:32768
  ds_read_b64_tr_b16 v[58:59], v7 offset:33792
  ds_read_b64_tr_b16 v[60:61], v7 offset:40960
  ds_read_b64_tr_b16 v[62:63], v7 offset:41984
  ds_read_b64_tr_b16 v[64:65], v7 offset:49152
  ds_read_b64_tr_b16 v[66:67], v7 offset:50176
  s_mul_i32 s30, s71, 56
  s_add_u32 s30, s30, 1610752
  v_and_b32 v8, 15, v0
  v_min_u32 v8, 13, v8
  v_lshlrev_b32 v8, 2, v8
L_MH:
  buffer_load_dword v9, v8, s[4:7], s30 offen sc1
  s_waitcnt vmcnt(0)
  v_cmp_eq_u32 vcc, 0, v9
  s_cbranch_vccz L_MHK
  s_sleep 1
  s_add_u32 s67, s67, 1
  s_cmp_lt_u32 s67, 524288
  s_cbranch_scc1 L_MH
  s_branch L_END
L_MHK:
  v_and_b32 v5, 1, v0
  v_lshlrev_b32 v5, 6, v5
  v_lshrrev_b32 v6, 4, v0
  v_lshl_add_u32 v5, v6, 4, v5
  s_mul_i32 s30, s71, 896
  s_add_u32 s30, s30, 8454144
  buffer_load_dwordx4 v[72:75], v5, s[4:7], s30 offen offset:0 sc1
  buffer_load_dwordx4 v[76:79], v5, s[4:7], s30 offen offset:128 sc1
  buffer_load_dwordx4 v[80:83], v5, s[4:7], s30 offen offset:256 sc1
  buffer_load_dwordx4 v[84:87], v5, s[4:7], s30 offen offset:384 sc1
  buffer_load_dwordx4 v[88:91], v5, s[4:7], s30 offen offset:512 sc1
  buffer_load_dwordx4 v[92:95], v5, s[4:7], s30 offen offset:640 sc1
  buffer_load_dwordx4 v[96:99], v5, s[4:7], s30 offen offset:768 sc1
  s_waitcnt vmcnt(0) lgkmcnt(0)
  v_mfma_f32_16x16x32_bf16 v[32:35], v[40:43], v[72:75], 0
  v_mfma_f32_16x16x32_bf16 v[32:35], v[44:47], v[76:79], v[32:35]
  v_mfma_f32_16x16x32_bf16 v[32:35], v[48:51], v[80:83], v[32:35]
  v_mfma_f32_16x16x32_bf16 v[32:35], v[52:55], v[84:87], v[32:35]
  v_mfma_f32_16x16x32_bf16 v[32:35], v[56:59], v[88:91], v[32:35]
  v_mfma_f32_16x16x32_bf16 v[32:35], v[60:63], v[92:95], v[32:35]
  v_mfma_f32_16x16x32_bf16 v[32:35], v[64:67], v[96:99], v[32:35]
  v_and_b32 v5, 15, v0
  v_lshlrev_b32 v5, 6, v5
  v_lshl_add_u32 v5, v6, 4, v5
  s_lshl_b32 s65, s66, 5
  s_lshl_b32 s30, s66, 10
  s_lshl_b32 s31, s24, 7
  s_add_u32 s30, s30, s31
  s_add_u32 s30, s30, 8519680
  s_mov_b32 exec_lo, 0x00030003
  s_mov_b32 exec_hi, 0x00030003
  s_nop 1
  buffer_store_dwordx4 v[32:35], v5, s[4:7], s30 offen sc1
  s_waitcnt vmcnt(0)
  s_lshl_b32 s31, s24, 2
  s_add_u32 s65, s65, s31
  s_add_u32 s65, s65, 1626112
  s_mov_b64 exec, 1
  v_mov_b32 v8, 1
  v_mov_b32 v9, 0
  buffer_store_dword v8, v9, s[4:7], s65 offen sc1
  s_mov_b64 exec, -1
  s_waitcnt vmcnt(0) lgkmcnt(0)
  s_endpgm
L_CB:
  s_setprio 3
  v_and_b32 v8, 7, v0
  v_lshrrev_b32 v9, 4, v0
  v_lshlrev_b32 v10, 4, v8
  v_and_b32 v11, 1, v9
  v_lshlrev_b32 v11, 3, v11
  v_add_u32 v10, v10, v11
  v_lshrrev_b32 v11, 1, v9
  v_lshlrev_b32 v2, 7, v11
  v_add_u32 v2, v2, v10
  s_lshl_b32 s30, s64, 8
  s_add_u32 s30, s30, 27648
  v_add_u32 v2, s30, v2
  v_lshrrev_b32 v11, 1, v9
  v_lshl_add_u32 v5, v11, 8, v10
  v_and_b32 v6, 3, v0
  v_lshlrev_b32 v6, 5, v6
  v_bfe_u32 v11, v0, 4, 1
  v_lshl_add_u32 v6, v11, 4, v6
  v_bfe_u32 v11, v0, 2, 1
  v_lshl_add_u32 v6, v11, 7, v6
  v_bfe_u32 v11, v0, 3, 1
  v_lshl_add_u32 v6, v11, 3, v6
  s_lshl_b32 s30, s64, 12
  s_add_u32 s30, s30, 3072
  v_add_u32 v12, s30, v1
  v_lshlrev_b32 v7, 10, v9
  v_and_b32 v11, 0xf0, v1
  v_add_u32 v7, v7, v11
  s_lshl_b32 s30, s64, 8
  v_add_u32 v7, s30, v7
  s_lshr_b32 s30, s71, 2
  s_mul_i32 s99, s30, 6144
  s_and_b32 s31, s71, 3
  s_lshl_b32 s31, s31, 10
  s_add_u32 s99, s99, s31
  s_and_b32 s31, s64, 1
  s_lshl_b32 s31, s31, 9
  s_add_u32 s99, s99, s31
  s_lshr_b32 s31, s64, 1
  s_lshl_b32 s31, s31, 7
  s_add_u32 s99, s99, s31
  s_lshl_b32 s31, s30, 11
  s_add_u32 s98, s99, s31
  s_lshl_b32 s31, s25, 15
  s_add_u32 s98, s98, s31
  s_add_u32 s98, s98, 83886080
  s_lshl_b32 s100, s25, 8
  s_lshl_b32 s30, s71, 4
  s_add_u32 s100, s100, s30
  s_and_b32 s30, s64, 1
  s_lshl_b32 s30, s30, 2
  s_add_u32 s100, s100, s30
  s_add_u32 s100, s100, 1613824
  s_lshl_b32 s101, s71, 10
  s_lshl_b32 s30, s64, 8
  s_add_u32 s101, s101, s30
  v_mov_b32 v20, 0
  v_mov_b32 v160, 0
  v_mov_b32 v24, 0x3f803f80
  v_mov_b32 v28, 0x3f003f00
  v_mov_b32 v21, 0
  v_mov_b32 v161, 0
  v_mov_b32 v25, 0x3f803f80
  v_mov_b32 v29, 0x3f003f00
  v_mov_b32 v22, 0
  v_mov_b32 v162, 0
  v_mov_b32 v26, 0x3f803f80
  v_mov_b32 v30, 0
  v_mov_b32 v23, 0
  v_mov_b32 v163, 0
  v_mov_b32 v27, 0x3f803f80
  v_mov_b32 v31, 0
  v_and_b32 v8, 15, v0
  v_cmp_eq_u32 vcc, 0, v8
  v_mov_b32 v9, 16256
  s_nop 1
  v_cndmask_b32 v20, v20, v9, vcc
  v_cmp_eq_u32 vcc, 1, v8
  v_mov_b32 v9, 1065353216
  s_nop 1
  v_cndmask_b32 v20, v20, v9, vcc
  v_cmp_eq_u32 vcc, 2, v8
  v_mov_b32 v9, 16256
  s_nop 1
  v_cndmask_b32 v21, v21, v9, vcc
  v_cmp_eq_u32 vcc, 3, v8
  v_mov_b32 v9, 1065353216
  s_nop 1
  v_cndmask_b32 v21, v21, v9, vcc
  v_cmp_eq_u32 vcc, 4, v8
  v_mov_b32 v9, 16256
  s_nop 1
  v_cndmask_b32 v22, v22, v9, vcc
  v_cmp_eq_u32 vcc, 5, v8
  v_mov_b32 v9, 1065353216
  s_nop 1
  v_cndmask_b32 v22, v22, v9, vcc
  v_cmp_eq_u32 vcc, 6, v8
  v_mov_b32 v9, 16256
  s_nop 1
  v_cndmask_b32 v23, v23, v9, vcc
  v_cmp_eq_u32 vcc, 7, v8
  v_mov_b32 v9, 1065353216
  s_nop 1
  v_cndmask_b32 v23, v23, v9, vcc
  v_cmp_eq_u32 vcc, 8, v8
  v_mov_b32 v9, 16256
  s_nop 1
  v_cndmask_b32 v160, v160, v9, vcc
  v_cmp_eq_u32 vcc, 9, v8
  v_mov_b32 v9, 1065353216
  s_nop 1
  v_cndmask_b32 v160, v160, v9, vcc
  v_cmp_eq_u32 vcc, 10, v8
  v_mov_b32 v9, 16256
  s_nop 1
  v_cndmask_b32 v161, v161, v9, vcc
  v_cmp_eq_u32 vcc, 11, v8
  v_mov_b32 v9, 1065353216
  s_nop 1
  v_cndmask_b32 v161, v161, v9, vcc
  v_cmp_eq_u32 vcc, 12, v8
  v_mov_b32 v9, 16256
  s_nop 1
  v_cndmask_b32 v162, v162, v9, vcc
  v_cmp_eq_u32 vcc, 13, v8
  v_mov_b32 v9, 1065353216
  s_nop 1
  v_cndmask_b32 v162, v162, v9, vcc
  v_cmp_eq_u32 vcc, 14, v8
  v_mov_b32 v9, 16256
  s_nop 1
  v_cndmask_b32 v163, v163, v9, vcc
  v_cmp_eq_u32 vcc, 15, v8
  v_mov_b32 v9, 1065353216
  s_nop 1
  v_cndmask_b32 v163, v163, v9, vcc
  v_mov_b32 v138, 0
  v_mov_b32 v139, 0
  v_mov_b32 v142, 0
  v_mov_b32 v143, 0
  v_mov_b32 v146, 0
  v_mov_b32 v147, 0
  v_mov_b32 v150, 0
  v_mov_b32 v151, 0
  s_lshl_b32 s30, s64, 12
  s_add_u32 s30, s30, 31744
  v_add_u32 v16, s30, v1
  s_lshl_b32 s30, s25, 8
  s_lshl_b32 s31, s71, 4
  s_add_u32 s30, s30, s31
  s_lshl_b32 s31, s64, 2
  s_add_u32 s30, s30, s31
  s_add_u32 s30, s30, 1617920
  v_mov_b32 v14, s30
  s_mul_i32 s30, s25, 384
  s_lshl_b32 s31, s64, 5
  s_add_u32 s30, s30, s31
  s_add_u32 s30, s30, 1572992
  s_mov_b64 exec, 0xff
  v_lshlrev_b32 v8, 2, v0
  v_add_u32 v14, s30, v8
  s_mov_b64 exec, -1
  s_lshl_b32 s78, s25, 16
  s_add_u32 s78, s78, 0
  s_add_u32 s78, s78, s101
  s_mul_i32 s79, s25, 98304
  s_add_u32 s79, s79, 524288
  s_lshl_b32 s80, s71, 14
  s_add_u32 s80, s80, s69
  s_lshr_b32 s65, s70, s25
  s_and_b32 s65, s65, 1
  s_lshl_b32 s65, s65, 13
  s_add_u32 s80, s80, s65
  s_mov_b32 s86, 0x3e0293ee
  s_mov_b32 s87, 0x3e0293ee
  s_lshl_b32 s88, s25, 2
  s_add_u32 s88, s88, s64
  s_lshl_b32 s88, s88, 13
  s_add_u32 s88, s88, 50331648
  s_lshl_b32 s89, s25, 4
  s_add_u32 s89, s89, s71
  s_lshl_b32 s89, s89, 2
  s_add_u32 s89, s89, s64
  s_lshl_b32 s89, s89, 12
  s_add_u32 s89, s89, 167772160
  s_lshl_b32 s30, s64, 3
  s_add_u32 s30, s30, 80
  v_mov_b32 v13, s30
  s_lshl_b32 s30, s25, 4
  s_add_u32 s30, s30, s71
  s_lshl_b32 s30, s30, 2
  s_add_u32 s30, s30, s64
  s_lshl_b32 s62, s30, 11
  s_add_u32 s62, s62, 201326592
  s_lshl_b32 s63, s30, 3
  s_add_u32 s63, s63, 1630208
  s_mov_b32 s28, -1
  s_mov_b32 s75, 28
  s_waitcnt lgkmcnt(0)
  s_branch L_W2
L_CB_LOOP:
  s_cmp_eq_u32 s27, 0
  s_cbranch_scc1 L_NWB
  s_cmp_lt_i32 s28, 1
  s_cbranch_scc1 L_NWB
  s_waitcnt vmcnt(0)
  buffer_store_dwordx4 v[120:123], v1, s[4:7], s76 offen offset:0 sc1
  buffer_store_dwordx4 v[124:127], v1, s[4:7], s76 offen offset:1024 sc1
  buffer_store_dwordx4 v[128:131], v1, s[4:7], s76 offen offset:2048 sc1
  buffer_store_dwordx4 v[132:135], v1, s[4:7], s76 offen offset:3072 sc1
L_NWB:
  v_mov_b32 v80, 0
  v_mov_b32 v81, 0
  v_mov_b32 v82, 0
  v_mov_b32 v83, 0
  s_mov_b64 exec, s[92:93]
  v_mov_b32 v80, 0xf149f2ca
  v_mov_b32 v81, 0xf149f2ca
  v_mov_b32 v82, 0xf149f2ca
  v_mov_b32 v83, 0xf149f2ca
  s_mov_b64 exec, -1
  s_and_b32 s30, s29, s20
  s_lshl_b32 s30, s30, 18
  s_add_u32 s76, s30, s88
  s_add_u32 s77, s76, 4096
  s_add_u32 s73, s28, 2
  s_cmp_lt_i32 s28, 1
  s_cbranch_scc1 L_W1f
  s_add_u32 s65, s28, 7
  s_and_b32 s65, s65, 7
  s_lshl_b32 s65, s65, 20
  s_add_u32 s65, s65, s62
  s_sleep 7
  s_waitcnt lgkmcnt(0)
  v_mov_b32 v8, -1
  v_mov_b32 v9, -1
  v_mov_b32 v10, -1
  v_mov_b32 v11, -1
  s_add_u32 s30, s28, 3
  s_and_b32 s30, s30, 3
  s_lshl_b32 s31, s30, 14
  s_add_u32 s31, s31, s78
  s_add_u32 s30, s28, 2
  s_and_b32 s30, s30, 3
  s_mul_i32 s30, s30, 24576
  s_add_u32 s30, s30, s79
  s_add_u32 s30, s30, s99
  s_mov_b64 exec, s[90:91]
  s_cmp_eq_u32 s27, 0
  s_cbranch_scc0 LS_7
  buffer_store_dwordx2 v[8:9], v5, s[4:7], s30 offen
  s_mov_b64 exec, s[92:93]
  buffer_store_dwordx2 v[8:9], v6, s[4:7], s31 offen
LD_8:
  s_mov_b64 exec, -1
L_W1f:
  buffer_load_dword v15, v14, s[4:7], 0 offen sc1
  s_mov_b32 s60, s84
  s_mov_b32 s61, s3
  s_and_b32 s30, s28, 3
  s_lshl_b32 s30, s30, 18
  s_add_u32 s84, s80, s30
  s_add_u32 s3, s84, 4096
  s_and_b32 s31, s29, 3
  s_lshl_b32 s31, s31, 14
  s_add_u32 s85, s78, s31
  s_cmp_lg_u32 s28, 63
  s_cbranch_scc1 L_NW63
  s_waitcnt vmcnt(0)
L_NW63:
  s_barrier
  ds_read_b128 v[64:67], v12 offset:0
  ds_read_b128 v[68:71], v12 offset:1024
  ds_read_b128 v[72:75], v12 offset:2048
  ds_read_b128 v[76:79], v12 offset:3072
  s_waitcnt lgkmcnt(3)
  v_mfma_f32_16x16x32_bf16 v[100:103], v[64:67], v[20:23], 0
  s_waitcnt lgkmcnt(2)
  v_mfma_f32_16x16x32_bf16 v[100:103], v[68:71], v[20:23], v[100:103]
  s_waitcnt lgkmcnt(1)
  v_mfma_f32_16x16x32_bf16 v[100:103], v[72:75], v[20:23], v[100:103]
  s_waitcnt lgkmcnt(0)
  v_mfma_f32_16x16x32_bf16 v[100:103], v[76:79], v[20:23], v[100:103]
  s_mov_b64 exec, s[90:91]
  s_nop 6
  v_cvt_pk_bf16_f32 v18, v100, v101
  v_cvt_pk_bf16_f32 v19, v102, v103
  v_min_u32 v18, -2, v18
  v_min_u32 v19, -2, v19
  s_cmp_eq_u32 s27, 0
  s_cbranch_scc0 LS_9
  buffer_store_dwordx2 v[18:19], v5, s[4:7], s83 offen
LD_10:
  s_cmp_lt_u32 s64, 2
  s_cbranch_scc1 L_EK
  s_cmp_eq_u32 s27, 0
  s_cbranch_scc0 LS_11
  buffer_store_dwordx2 v[18:19], v5, s[4:7], s74 offen
LD_12:
L_EK:
  s_mov_b64 exec, -1
  s_cmp_eq_u32 s28, 63
  s_cbranch_scc1 L_W1a
  s_cmp_lg_u32 s28, 0
  s_cbranch_scc1 L_CF1
L_CF0:
  buffer_load_dword v15, v14, s[4:7], 0 offen sc1
  s_waitcnt vmcnt(0)
  v_cmp_eq_u32 vcc, 0, v15
  s_cbranch_vccz L_CF0K
  s_sleep 1
  s_add_u32 s67, s67, 1
  s_cmp_lt_u32 s67, 524288
  s_cbranch_scc1 L_CF0
  s_branch L_END
L_CF0K:
  s_add_u32 s31, s88, 4096
  buffer_load_dwordx4 v[32:35], v1, s[4:7], s88 offen offset:0 sc1
  buffer_load_dwordx4 v[36:39], v1, s[4:7], s88 offen offset:1024 sc1
  buffer_load_dwordx4 v[40:43], v1, s[4:7], s88 offen offset:2048 sc1
  buffer_load_dwordx4 v[44:47], v1, s[4:7], s88 offen offset:3072 sc1
  buffer_load_dwordx4 v[48:51], v1, s[4:7], s31 offen offset:0 sc1
  buffer_load_dwordx4 v[52:55], v1, s[4:7], s31 offen offset:1024 sc1
  buffer_load_dwordx4 v[56:59], v1, s[4:7], s31 offen offset:2048 sc1
  buffer_load_dwordx4 v[60:63], v1, s[4:7], s31 offen offset:3072 sc1
  buffer_load_dwordx4 v[120:123], v1, s[4:7], s89 offen offset:0 sc1
  buffer_load_dwordx4 v[124:127], v1, s[4:7], s89 offen offset:1024 sc1
  buffer_load_dwordx4 v[128:131], v1, s[4:7], s89 offen offset:2048 sc1
  buffer_load_dwordx4 v[132:135], v1, s[4:7], s89 offen offset:3072 sc1
  s_cmp_eq_u32 s27, 0
  s_cbranch_scc1 L_CF1
  s_waitcnt vmcnt(0)
  buffer_store_dwordx4 v[120:123], v1, s[4:7], s89 offen offset:0 sc1
  buffer_store_dwordx4 v[124:127], v1, s[4:7], s89 offen offset:1024 sc1
  buffer_store_dwordx4 v[128:131], v1, s[4:7], s89 offen offset:2048 sc1
  buffer_store_dwordx4 v[132:135], v1, s[4:7], s89 offen offset:3072 sc1
L_CF1:
  s_sleep 1
  s_nop 7
  buffer_load_dwordx4 v[64:67], v1, s[4:7], s82 offen offset:0 sc1
  buffer_load_dwordx4 v[68:71], v1, s[4:7], s82 offen offset:1024 sc1
  buffer_load_dwordx4 v[72:75], v1, s[4:7], s82 offen offset:2048 sc1
  buffer_load_dwordx4 v[76:79], v1, s[4:7], s82 offen offset:3072 sc1
L_AW0:
  s_waitcnt vmcnt(3)
  v_max3_u32 v10, v64, v65, v66
  v_max_u32 v10, v10, v67
  v_cmp_eq_u32 vcc, -1, v10
  s_cbranch_vccnz L_AR0
  v_mfma_f32_16x16x32_bf16 v[84:87], v[32:35], v[64:67], 0
  v_mfma_f32_16x16x32_bf16 v[88:91], v[48:51], v[64:67], 0
  v_mfma_f32_16x16x32_bf16 v[80:83], v[64:67], v[64:67], v[80:83]
L_AW1:
  s_waitcnt vmcnt(2)
  v_max3_u32 v10, v68, v69, v70
  v_max_u32 v10, v10, v71
  v_cmp_eq_u32 vcc, -1, v10
  s_cbranch_vccnz L_AR1
  v_mfma_f32_16x16x32_bf16 v[84:87], v[36:39], v[68:71], v[84:87]
  v_mfma_f32_16x16x32_bf16 v[88:91], v[52:55], v[68:71], v[88:91]
  v_mfma_f32_16x16x32_bf16 v[80:83], v[68:71], v[68:71], v[80:83]
L_AW2:
  s_waitcnt vmcnt(1)
  v_max3_u32 v10, v72, v73, v74
  v_max_u32 v10, v10, v75
  v_cmp_eq_u32 vcc, -1, v10
  s_cbranch_vccnz L_AR2
  v_mfma_f32_16x16x32_bf16 v[84:87], v[40:43], v[72:75], v[84:87]
  v_mfma_f32_16x16x32_bf16 v[88:91], v[56:59], v[72:75], v[88:91]
  v_mfma_f32_16x16x32_bf16 v[80:83], v[72:75], v[72:75], v[80:83]
L_AW3:
  s_waitcnt vmcnt(0)
  v_max3_u32 v10, v76, v77, v78
  v_max_u32 v10, v10, v79
  v_cmp_eq_u32 vcc, -1, v10
  s_cbranch_vccnz L_AR3
  v_mfma_f32_16x16x32_bf16 v[84:87], v[44:47], v[76:79], v[84:87]
  v_mfma_f32_16x16x32_bf16 v[88:91], v[60:63], v[76:79], v[88:91]
  v_mfma_f32_16x16x32_bf16 v[80:83], v[76:79], v[76:79], v[80:83]
  s_nop 1
L_FGC:
  v_cmp_gt_u32 vcc, s73, v15
  s_cbranch_vccnz L_FGR
  buffer_load_dwordx4 v[32:35], v1, s[4:7], s76 offen offset:0 sc1
  v_max3_f32 v8, v84, v85, v86
  v_max3_f32 v9, v87, v88, v89
  v_max3_f32 v8, v8, v90, v91
  v_max3_f32 v9, v9, v80, v81
  v_max3_f32 v8, v8, v82, v83
  v_max_f32 v8, v8, v9
  v_mov_b32 v9, v8
  s_nop 0
  buffer_load_dwordx4 v[36:39], v1, s[4:7], s76 offen offset:1024 sc1
  v_permlane32_swap_b32 v8, v9
  s_nop 0
  v_max_f32 v8, v8, v9
  v_mov_b32 v9, v8
  s_nop 1
  v_permlane16_swap_b32 v8, v9
  s_nop 0
  v_max_f32 v8, v8, v9
  v_mul_f32 v8, s86, v8
  v_mul_f32 v9, 1.0, v8
  buffer_load_dwordx4 v[40:43], v1, s[4:7], s76 offen offset:2048 sc1
  v_pk_fma_f32 v[84:85], v[84:85], s[86:87], v[8:9] neg_lo:[0,0,1] neg_hi:[0,0,1]
  v_pk_fma_f32 v[86:87], v[86:87], s[86:87], v[8:9] neg_lo:[0,0,1] neg_hi:[0,0,1]
  v_pk_fma_f32 v[88:89], v[88:89], s[86:87], v[8:9] neg_lo:[0,0,1] neg_hi:[0,0,1]
  v_pk_fma_f32 v[90:91], v[90:91], s[86:87], v[8:9] neg_lo:[0,0,1] neg_hi:[0,0,1]
  v_pk_fma_f32 v[80:81], v[80:81], s[86:87], v[8:9] neg_lo:[0,0,1] neg_hi:[0,0,1]
  v_pk_fma_f32 v[82:83], v[82:83], s[86:87], v[8:9] neg_lo:[0,0,1] neg_hi:[0,0,1]
  v_exp_f32 v84, v84
  v_exp_f32 v85, v85
  v_exp_f32 v86, v86
  v_exp_f32 v87, v87
  buffer_load_dwordx4 v[44:47], v1, s[4:7], s76 offen offset:3072 sc1
  v_exp_f32 v88, v88
  v_exp_f32 v89, v89
  v_exp_f32 v90, v90
  v_exp_f32 v91, v91
L_VMP:
  ds_read_b64 v[152:153], v13
  ds_read_b128 v[136:139], v16 offset:0
  ds_read_b128 v[140:143], v16 offset:1024
  ds_read_b128 v[144:147], v16 offset:2048
  ds_read_b128 v[148:151], v16 offset:3072
  s_cmp_eq_u32 s72, 1
  s_cbranch_scc1 L_VMC
  v_exp_f32 v80, v80
  v_exp_f32 v81, v81
  v_exp_f32 v82, v82
  v_exp_f32 v83, v83
  buffer_load_dwordx4 v[48:51], v1, s[4:7], s77 offen offset:0 sc1
  v_cvt_pk_bf16_f32 v92, v84, v85
  v_cvt_pk_bf16_f32 v93, v86, v87
  v_cvt_pk_bf16_f32 v94, v88, v89
  v_cvt_pk_bf16_f32 v95, v90, v91
  v_cvt_pk_bf16_f32 v96, v80, v81
  v_cvt_pk_bf16_f32 v97, v82, v83
  v_cvt_pk_bf16_f32 v98, v80, v81
  v_cvt_pk_bf16_f32 v99, v82, v83
  buffer_load_dwordx4 v[52:55], v1, s[4:7], s77 offen offset:1024 sc1
  v_mfma_f32_16x16x32_bf16 v[116:119], v[24:27], v[92:95], 0
  v_mfma_f32_16x16x32_bf16 v[100:103], v[120:123], v[92:95], 0
  v_permlane32_swap_b32 v98, v96
  v_permlane32_swap_b32 v99, v97
  v_mfma_f32_16x16x32_bf16 v[104:107], v[124:127], v[92:95], 0
  v_mov_b32 v98, v96
  v_mov_b32 v99, v97
  v_mfma_f32_16x16x32_bf16 v[108:111], v[128:131], v[92:95], 0
  v_mfma_f32_16x16x32_bf16 v[112:115], v[132:135], v[92:95], 0
  v_mfma_f32_16x16x32_bf16 v[116:119], v[28:31], v[96:99], v[116:119]
  buffer_load_dwordx4 v[56:59], v1, s[4:7], s77 offen offset:2048 sc1
L_VMC:
  s_waitcnt lgkmcnt(0)
  v_min_u32 v10, v152, v153
  v_cmp_gt_u32 vcc, s29, v10
  s_cbranch_vccz L_VMK
  s_mov_b32 s72, 1
  s_add_u32 s67, s67, 1
  s_cmp_lt_u32 s67, 524288
  s_cbranch_scc1 L_VMP
  s_branch L_END
L_VMK:
  v_mfma_f32_16x16x32_bf16 v[100:103], v[136:139], v[96:99], v[100:103]
  v_mfma_f32_16x16x32_bf16 v[104:107], v[140:143], v[96:99], v[104:107]
  v_mfma_f32_16x16x32_bf16 v[108:111], v[144:147], v[96:99], v[108:111]
  v_mfma_f32_16x16x32_bf16 v[112:115], v[148:151], v[96:99], v[112:115]
  v_rcp_f32 v8, v116
  v_rcp_f32 v9, v116
  buffer_load_dwordx4 v[60:63], v1, s[4:7], s77 offen offset:3072 sc1
  s_nop 1
  s_mov_b64 exec, s[90:91]
  v_pk_mul_f32 v[100:101], v[100:101], v[8:9]
  v_pk_mul_f32 v[102:103], v[102:103], v[8:9]
  v_cvt_pk_bf16_f32 v100, v100, v101
  v_cvt_pk_bf16_f32 v101, v102, v103
  ds_write_b64 v2, v[100:101] offset:0
  v_pk_mul_f32 v[104:105], v[104:105], v[8:9]
  v_pk_mul_f32 v[106:107], v[106:107], v[8:9]
  v_cvt_pk_bf16_f32 v104, v104, v105
  v_cvt_pk_bf16_f32 v105, v106, v107
  ds_write_b64 v2, v[104:105] offset:1024
  v_pk_mul_f32 v[108:109], v[108:109], v[8:9]
  v_pk_mul_f32 v[110:111], v[110:111], v[8:9]
  v_cvt_pk_bf16_f32 v108, v108, v109
  v_cvt_pk_bf16_f32 v109, v110, v111
  ds_write_b64 v2, v[108:109] offset:2048
  v_pk_mul_f32 v[112:113], v[112:113], v[8:9]
  v_pk_mul_f32 v[114:115], v[114:115], v[8:9]
  v_cvt_pk_bf16_f32 v112, v112, v113
  v_cvt_pk_bf16_f32 v113, v114, v115
  ds_write_b64 v2, v[112:113] offset:3072
  s_mov_b64 exec, -1
  s_waitcnt lgkmcnt(0)
  s_barrier
  s_and_b32 s30, s29, 7
  s_lshl_b32 s30, s30, 21
  s_add_u32 s76, s30, s89
  s_barrier
L_W1:
  s_cmp_eq_u32 s28, 63
  s_cbranch_scc1 L_W1m
  s_branch L_W1m
  s_mov_b64 exec, 1
  v_mov_b32 v8, s28
  v_mov_b32 v9, s28
  v_mov_b32 v10, 0
  s_cmp_eq_u32 s27, 0
  s_cbranch_scc0 LS_13
  buffer_store_dwordx2 v[8:9], v10, s[4:7], s63 offen
LD_14:
  s_mov_b64 exec, -1
L_W1m:
  s_cmp_lt_u32 s64, 2
  s_cbranch_scc1 FK_15
  s_mov_b64 exec, 1
  v_mov_b32 v8, 0
  s_cmp_eq_u32 s27, 0
  s_cbranch_scc0 LS_16
  buffer_store_dword v4, v8, s[4:7], s100 offen
LD_17:
  s_mov_b64 exec, -1
FK_15:
L_W1a:
  s_cmp_lg_u32 s28, 63
  s_cbranch_scc1 L_W1b
  s_waitcnt vmcnt(0)
  s_cmp_lt_u32 s64, 2
  s_cbranch_scc1 FK_18
  s_mov_b64 exec, 1
  v_mov_b32 v8, 0
  s_cmp_eq_u32 s27, 0
  s_cbranch_scc0 LS_19
  buffer_store_dword v4, v8, s[4:7], s100 offen
LD_20:
  s_mov_b64 exec, -1
FK_18:
  s_branch L_CB_DONE
L_W1b:
  s_sleep 7
  buffer_load_dwordx4 v[152:155], v7, s[4:7], s84 offen sc1
  buffer_load_dwordx4 v[156:159], v7, s[4:7], s3 offen sc1
  s_sleep 1
  buffer_load_dwordx4 v[120:123], v1, s[4:7], s76 offen offset:0 sc1
  buffer_load_dwordx4 v[124:127], v1, s[4:7], s76 offen offset:1024 sc1
  buffer_load_dwordx4 v[128:131], v1, s[4:7], s76 offen offset:2048 sc1
  buffer_load_dwordx4 v[132:135], v1, s[4:7], s76 offen offset:3072 sc1
  s_waitcnt vmcnt(5)
  v_mfma_f32_16x16x32_bf16 v[100:103], v[20:23], v[152:155], 0
  v_max3_u32 v10, v152, v153, v154
  s_waitcnt vmcnt(4)
  v_mfma_f32_16x16x32_bf16 v[100:103], v[20:23], v[156:159], v[100:103]
  v_max3_u32 v11, v155, v156, v157
  v_max3_u32 v10, v10, v158, v159
  v_max_u32 v10, v10, v11
  v_cmp_eq_u32 vcc, -1, v10
  s_cbranch_vccz L_BOK
L_BP:
  s_add_u32 s68, s68, 1
  buffer_load_dwordx4 v[152:155], v7, s[4:7], s84 offen sc1
  buffer_load_dwordx4 v[156:159], v7, s[4:7], s3 offen sc1
  s_waitcnt vmcnt(1)
  v_mfma_f32_16x16x32_bf16 v[100:103], v[20:23], v[152:155], 0
  v_max3_u32 v10, v152, v153, v154
  s_waitcnt vmcnt(0)
  v_mfma_f32_16x16x32_bf16 v[100:103], v[20:23], v[156:159], v[100:103]
  v_max3_u32 v11, v155, v156, v157
  v_max3_u32 v10, v10, v158, v159
  v_max_u32 v10, v10, v11
  v_cmp_eq_u32 vcc, -1, v10
  s_cbranch_vccz L_BOK
  s_add_u32 s67, s67, 1
  s_cmp_lt_u32 s67, 524288
  s_cbranch_scc1 L_BP
  s_branch L_END
L_BOK:
  s_mov_b64 exec, s[92:93]
  s_nop 1
  v_cvt_pk_bf16_f32 v100, v100, v101
  v_cvt_pk_bf16_f32 v101, v102, v103
  v_min_u32 v100, -2, v100
  v_min_u32 v101, -2, v101
  s_cmp_eq_u32 s27, 0
  s_cbranch_scc0 LS_21
  buffer_store_dwordx2 v[100:101], v6, s[4:7], s85 offen
LD_22:
  s_mov_b64 exec, -1
  s_barrier
  s_branch L_W2b
L_W2:
  s_barrier
L_W2b:
  s_add_u32 s28, s28, 1
  s_add_u32 s29, s28, 1
  v_mov_b32 v4, s29
  s_mov_b32 s72, 0
  s_and_b32 s30, s28, 3
  s_mul_i32 s31, s30, 24576
  s_add_u32 s31, s31, s79
  s_add_u32 s83, s31, s99
  s_mul_i32 s65, s64, 6144
  s_add_u32 s82, s31, s65
  s_and_b32 s74, s28, s20
  s_lshl_b32 s74, s74, 18
  s_add_u32 s74, s74, s98
  s_branch L_CB_LOOP
L_FGR:
  s_add_u32 s68, s68, 16777216
  buffer_load_dword v15, v14, s[4:7], 0 offen sc1
  s_waitcnt vmcnt(0)
  s_add_u32 s67, s67, 1
  s_cmp_lt_u32 s67, 524288
  s_cbranch_scc1 L_FGC
  s_branch L_END
L_CB_DONE:
  s_waitcnt vmcnt(0) lgkmcnt(0)
  s_endpgm
L_BULK:
  s_cmp_ge_u32 s24, 8
  s_cbranch_scc1 L_BV
L_XPW0:
  s_lshr_b32 s88, s24, 2
  s_lshl_b32 s30, s24, 2
  s_add_u32 s30, s30, 0
  v_mov_b32 v3, s30
  v_lshrrev_b32 v5, 5, v0
  v_lshlrev_b32 v2, 11, v5
  v_and_b32 v6, 31, v0
  v_lshl_add_u32 v2, v6, 3, v2
  s_lshl_b32 s30, s24, 8
  s_add_u32 s30, s30, 3072
  v_add_u32 v2, s30, v2
  s_lshl_b32 s30, s24, 12
  s_add_u32 s30, s30, 3072
  v_add_u32 v7, s30, v1
  v_and_b32 v4, 7, v0
  v_lshlrev_b32 v4, 5, v4
  v_bfe_u32 v6, v0, 4, 1
  v_lshl_add_u32 v4, v6, 4, v4
  v_lshl_add_u32 v4, v5, 8, v4
  v_bfe_u32 v6, v0, 3, 1
  v_lshl_add_u32 v4, v6, 3, v4
  s_lshl_b32 s79, s25, 2
  s_lshr_b32 s30, s71, 2
  s_add_u32 s79, s79, s30
  s_lshl_b32 s79, s79, 13
  s_and_b32 s30, s71, 3
  s_lshl_b32 s30, s30, 10
  s_add_u32 s79, s79, s30
  s_and_b32 s31, s24, 1
  s_lshl_b32 s30, s31, 9
  s_add_u32 s79, s79, s30
  s_lshr_b32 s65, s24, 1
  s_lshl_b32 s30, s65, 24
  s_add_u32 s79, s79, s30
  s_add_u32 s79, s79, 33554432
  s_mul_i32 s83, s25, 384
  s_lshl_b32 s30, s65, 7
  s_add_u32 s83, s83, s30
  s_lshl_b32 s30, s71, 3
  s_add_u32 s83, s83, s30
  s_lshl_b32 s30, s31, 2
  s_add_u32 s83, s83, s30
  s_add_u32 s83, s83, 1572864
  s_lshl_b32 s78, s24, 12
  s_add_u32 s78, s78, 25165824
  s_add_u32 s87, s78, 32768
  s_mov_b32 s80, s71
  s_mov_b32 s84, 0x3e0293ee
  s_mov_b32 s86, 0
  s_mov_b32 s89, 54
  s_mov_b32 s98, 0
  s_mov_b32 s81, 0
  s_mov_b32 s82, 0
  v_lshlrev_b32 v8, 2, v0
  s_lshl_b32 s30, s86, 8
  s_add_u32 s30, s30, 1609728
L_FG0:
  buffer_load_dword v9, v8, s[4:7], s30 offen sc1
  s_waitcnt vmcnt(0)
  v_cmp_eq_u32 vcc, 0, v9
  s_cbranch_vccz L_FG0K
  s_sleep 1
  s_add_u32 s67, s67, 1
  s_cmp_lt_u32 s67, 524288
  s_cbranch_scc1 L_FG0
  s_branch L_END
L_FG0K:
  buffer_load_dwordx4 v[136:139], v1, s[4:7], s78 offen offset:0
  buffer_load_dwordx4 v[140:143], v1, s[4:7], s78 offen offset:1024
  buffer_load_dwordx4 v[144:147], v1, s[4:7], s78 offen offset:2048
  buffer_load_dwordx4 v[148:151], v1, s[4:7], s78 offen offset:3072
  buffer_load_dwordx4 v[152:155], v1, s[4:7], s87 offen offset:0
  buffer_load_dwordx4 v[156:159], v1, s[4:7], s87 offen offset:1024
  buffer_load_dwordx4 v[160:163], v1, s[4:7], s87 offen offset:2048
  buffer_load_dwordx4 v[164:167], v1, s[4:7], s87 offen offset:3072
  s_add_u32 s78, s78, 65536
  s_add_u32 s87, s87, 65536
L_XP:
  v_mov_b32 v6, 0
  ds_read_b128 v[8:11], v6 offset:64
  ds_read_b128 v[12:15], v6 offset:32
  s_waitcnt lgkmcnt(0)
  v_min3_u32 v8, v8, v9, v10
  v_min_u32 v8, v8, v11
  v_min3_u32 v12, v12, v13, v14
  v_min_u32 v12, v12, v15
  v_readfirstlane_b32 s31, v8
  v_readfirstlane_b32 s65, v12
  s_cmp_gt_u32 s31, s80
  s_cbranch_scc1 L_PT
  s_cmp_ge_u32 s86, 64
  s_cbranch_scc1 L_XN
  s_add_u32 s31, s31, 9
  s_add_u32 s65, s65, 16
  s_min_u32 s31, s31, s65
  s_cmp_ge_u32 s86, s31
  s_cbranch_scc1 L_XN
  s_sub_u32 s30, s86, s81
  s_cmp_lt_u32 s86, 5
  s_cselect_b32 s31, 1, 2
  s_cmp_lt_u32 s30, s31
  s_cbranch_scc1 L_XPG
L_XN:
  s_cmp_lt_u32 s81, s86
  s_cbranch_scc1 L_RED
  s_cmp_eq_u32 s82, 0
  s_cbranch_scc1 FF_23
  s_waitcnt vmcnt(0)
  s_mov_b64 exec, 1
  v_mov_b32 v8, 0
  v_mov_b32 v9, s82
  s_cmp_eq_u32 s27, 0
  s_cbranch_scc0 LS_24
  buffer_store_dword v9, v8, s[4:7], s83 offen
LD_25:
  s_mov_b64 exec, -1
  s_mov_b32 s82, 0
FF_23:
  s_cmp_lt_u32 s86, 64
  s_cbranch_scc1 L_XPS
  s_cmp_ge_u32 s80, 64
  s_cbranch_scc1 L_XP_DONE
L_XPS:
  s_sleep 2
  s_add_u32 s67, s67, 1
  s_cmp_lt_u32 s67, 524288
  s_cbranch_scc1 L_XP
  s_branch L_END
L_XPG:
  s_add_u32 s85, s86, 1
  s_and_b32 s30, s85, 15
  s_cmp_lg_u32 s30, 0
  s_cbranch_scc1 L_XPG2
  s_cmp_ge_u32 s85, 64
  s_cbranch_scc1 L_XPG2
  s_lshr_b32 s65, s85, 4
  v_lshlrev_b32 v8, 2, v0
  s_lshl_b32 s30, s65, 8
  s_add_u32 s30, s30, 1609728
L_FG1:
  buffer_load_dword v9, v8, s[4:7], s30 offen sc1
  s_waitcnt vmcnt(0)
  v_cmp_eq_u32 vcc, 0, v9
  s_cbranch_vccz L_FG1K
  s_sleep 1
  s_add_u32 s67, s67, 1
  s_cmp_lt_u32 s67, 524288
  s_cbranch_scc1 L_FG1
  s_branch L_END
L_FG1K:
L_XPG2:
  s_and_b32 s30, s86, 1
  s_mul_i32 s30, s30, 49152
  v_add_u32 v5, s30, v2
  s_max_i32 s66, s86, 1
  s_sub_u32 s66, s66, 1
  s_waitcnt vmcnt(7)
  v_mfma_f32_16x16x32_bf16 v[16:19], v[40:43], v[136:139], 0
  v_mfma_f32_16x16x32_bf16 v[20:23], v[56:59], v[136:139], 0
  v_mfma_f32_16x16x32_bf16 v[24:27], v[72:75], v[136:139], 0
  v_mfma_f32_16x16x32_bf16 v[28:31], v[88:91], v[136:139], 0
  v_mfma_f32_16x16x32_bf16 v[32:35], v[104:107], v[136:139], 0
  v_mfma_f32_16x16x32_bf16 v[36:39], v[120:123], v[136:139], 0
  buffer_load_dwordx4 v[136:139], v1, s[4:7], s78 offen offset:0
  s_waitcnt vmcnt(7)
  v_mfma_f32_16x16x32_bf16 v[16:19], v[44:47], v[140:143], v[16:19]
  v_mfma_f32_16x16x32_bf16 v[20:23], v[60:63], v[140:143], v[20:23]
  v_mfma_f32_16x16x32_bf16 v[24:27], v[76:79], v[140:143], v[24:27]
  v_mfma_f32_16x16x32_bf16 v[28:31], v[92:95], v[140:143], v[28:31]
  v_mfma_f32_16x16x32_bf16 v[32:35], v[108:111], v[140:143], v[32:35]
  v_mfma_f32_16x16x32_bf16 v[36:39], v[124:127], v[140:143], v[36:39]
  buffer_load_dwordx4 v[140:143], v1, s[4:7], s78 offen offset:1024
  s_waitcnt vmcnt(7)
  v_mfma_f32_16x16x32_bf16 v[16:19], v[48:51], v[144:147], v[16:19]
  v_mfma_f32_16x16x32_bf16 v[20:23], v[64:67], v[144:147], v[20:23]
  v_mfma_f32_16x16x32_bf16 v[24:27], v[80:83], v[144:147], v[24:27]
  v_mfma_f32_16x16x32_bf16 v[28:31], v[96:99], v[144:147], v[28:31]
  v_mfma_f32_16x16x32_bf16 v[32:35], v[112:115], v[144:147], v[32:35]
  v_mfma_f32_16x16x32_bf16 v[36:39], v[128:131], v[144:147], v[36:39]
  buffer_load_dwordx4 v[144:147], v1, s[4:7], s78 offen offset:2048
  s_waitcnt vmcnt(7)
  v_mfma_f32_16x16x32_bf16 v[16:19], v[52:55], v[148:151], v[16:19]
  v_mfma_f32_16x16x32_bf16 v[20:23], v[68:71], v[148:151], v[20:23]
  v_mfma_f32_16x16x32_bf16 v[24:27], v[84:87], v[148:151], v[24:27]
  v_mfma_f32_16x16x32_bf16 v[28:31], v[100:103], v[148:151], v[28:31]
  v_mfma_f32_16x16x32_bf16 v[32:35], v[116:119], v[148:151], v[32:35]
  v_mfma_f32_16x16x32_bf16 v[36:39], v[132:135], v[148:151], v[36:39]
  buffer_load_dwordx4 v[148:151], v1, s[4:7], s78 offen offset:3072
  v_mov_b32 v6, 128
L_XC:
  ds_read_b128 v[8:11], v6
  ds_read_b128 v[12:15], v6 offset:16
  s_waitcnt lgkmcnt(0)
  v_min3_u32 v8, v8, v9, v10
  v_min3_u32 v11, v11, v12, v13
  v_min3_u32 v8, v8, v14, v15
  v_min_u32 v8, v8, v11
  v_cmp_gt_u32 vcc, s66, v8
  s_cbranch_vccz L_XCK
  s_add_u32 s67, s67, 1
  s_cmp_lt_u32 s67, 524288
  s_cbranch_scc1 L_XC
  s_branch L_END
L_XCK:
  s_nop 1
  v_cvt_pk_bf16_f32 v16, v16, v17
  v_cvt_pk_bf16_f32 v17, v18, v19
  ds_write_b64 v5, v[16:17] offset:0
  v_cvt_pk_bf16_f32 v20, v20, v21
  v_cvt_pk_bf16_f32 v21, v22, v23
  ds_write_b64 v5, v[20:21] offset:4096
  v_cvt_pk_bf16_f32 v24, v24, v25
  v_cvt_pk_bf16_f32 v25, v26, v27
  ds_write_b64 v5, v[24:25] offset:8192
  v_cvt_pk_bf16_f32 v28, v28, v29
  v_cvt_pk_bf16_f32 v29, v30, v31
  ds_write_b64 v5, v[28:29] offset:12288
  v_cvt_pk_bf16_f32 v32, v32, v33
  v_cvt_pk_bf16_f32 v33, v34, v35
  ds_write_b64 v5, v[32:33] offset:16384
  v_cvt_pk_bf16_f32 v36, v36, v37
  v_cvt_pk_bf16_f32 v37, v38, v39
  ds_write_b64 v5, v[36:37] offset:20480
  s_waitcnt vmcnt(7)
  v_mfma_f32_16x16x32_bf16 v[16:19], v[40:43], v[152:155], 0
  v_mfma_f32_16x16x32_bf16 v[20:23], v[56:59], v[152:155], 0
  v_mfma_f32_16x16x32_bf16 v[24:27], v[72:75], v[152:155], 0
  v_mfma_f32_16x16x32_bf16 v[28:31], v[88:91], v[152:155], 0
  v_mfma_f32_16x16x32_bf16 v[32:35], v[104:107], v[152:155], 0
  v_mfma_f32_16x16x32_bf16 v[36:39], v[120:123], v[152:155], 0
  buffer_load_dwordx4 v[152:155], v1, s[4:7], s87 offen offset:0
  s_waitcnt vmcnt(7)
  v_mfma_f32_16x16x32_bf16 v[16:19], v[44:47], v[156:159], v[16:19]
  v_mfma_f32_16x16x32_bf16 v[20:23], v[60:63], v[156:159], v[20:23]
  v_mfma_f32_16x16x32_bf16 v[24:27], v[76:79], v[156:159], v[24:27]
  v_mfma_f32_16x16x32_bf16 v[28:31], v[92:95], v[156:159], v[28:31]
  v_mfma_f32_16x16x32_bf16 v[32:35], v[108:111], v[156:159], v[32:35]
  v_mfma_f32_16x16x32_bf16 v[36:39], v[124:127], v[156:159], v[36:39]
  buffer_load_dwordx4 v[156:159], v1, s[4:7], s87 offen offset:1024
  s_waitcnt vmcnt(7)
  v_mfma_f32_16x16x32_bf16 v[16:19], v[48:51], v[160:163], v[16:19]
  v_mfma_f32_16x16x32_bf16 v[20:23], v[64:67], v[160:163], v[20:23]
  v_mfma_f32_16x16x32_bf16 v[24:27], v[80:83], v[160:163], v[24:27]
  v_mfma_f32_16x16x32_bf16 v[28:31], v[96:99], v[160:163], v[28:31]
  v_mfma_f32_16x16x32_bf16 v[32:35], v[112:115], v[160:163], v[32:35]
  v_mfma_f32_16x16x32_bf16 v[36:39], v[128:131], v[160:163], v[36:39]
  buffer_load_dwordx4 v[160:163], v1, s[4:7], s87 offen offset:2048
  s_waitcnt vmcnt(7)
  v_mfma_f32_16x16x32_bf16 v[16:19], v[52:55], v[164:167], v[16:19]
  v_mfma_f32_16x16x32_bf16 v[20:23], v[68:71], v[164:167], v[20:23]
  v_mfma_f32_16x16x32_bf16 v[24:27], v[84:87], v[164:167], v[24:27]
  v_mfma_f32_16x16x32_bf16 v[28:31], v[100:103], v[164:167], v[28:31]
  v_mfma_f32_16x16x32_bf16 v[32:35], v[116:119], v[164:167], v[32:35]
  v_mfma_f32_16x16x32_bf16 v[36:39], v[132:135], v[164:167], v[36:39]
  buffer_load_dwordx4 v[164:167], v1, s[4:7], s87 offen offset:3072
  s_cmp_eq_u32 s82, 0
  s_cbranch_scc1 FF_26
  s_mov_b64 exec, 1
  v_mov_b32 v8, 0
  v_mov_b32 v9, s82
  s_cmp_eq_u32 s27, 0
  s_cbranch_scc0 LS_27
  buffer_store_dword v9, v8, s[4:7], s83 offen
LD_28:
  s_mov_b64 exec, -1
  s_mov_b32 s82, 0
FF_26:
  s_nop 1
  v_cvt_pk_bf16_f32 v16, v16, v17
  v_cvt_pk_bf16_f32 v17, v18, v19
  ds_write_b64 v5, v[16:17] offset:24576
  v_cvt_pk_bf16_f32 v20, v20, v21
  v_cvt_pk_bf16_f32 v21, v22, v23
  ds_write_b64 v5, v[20:21] offset:28672
  v_cvt_pk_bf16_f32 v24, v24, v25
  v_cvt_pk_bf16_f32 v25, v26, v27
  ds_write_b64 v5, v[24:25] offset:32768
  v_cvt_pk_bf16_f32 v28, v28, v29
  v_cvt_pk_bf16_f32 v29, v30, v31
  ds_write_b64 v5, v[28:29] offset:36864
  v_cvt_pk_bf16_f32 v32, v32, v33
  v_cvt_pk_bf16_f32 v33, v34, v35
  ds_write_b64 v5, v[32:33] offset:40960
  v_cvt_pk_bf16_f32 v36, v36, v37
  v_cvt_pk_bf16_f32 v37, v38, v39
  ds_write_b64 v5, v[36:37] offset:45056
  s_add_u32 s78, s78, 65536
  s_add_u32 s87, s87, 65536
  v_mov_b32 v5, s85
  ds_write_b32 v3, v5 offset:0
  s_add_u32 s86, s86, 1
  s_branch L_XP
L_RED:
  s_add_u32 s85, s81, 1
  v_mov_b32 v5, s85
  s_cmp_ge_u32 s24, 6
  s_cbranch_scc1 L_XRS
  s_cmp_eq_u32 s82, 0
  s_cbranch_scc1 FF_29
  s_waitcnt vmcnt(0)
  s_mov_b64 exec, 1
  v_mov_b32 v8, 0
  v_mov_b32 v9, s82
  s_cmp_eq_u32 s27, 0
  s_cbranch_scc0 LS_30
  buffer_store_dword v9, v8, s[4:7], s83 offen
LD_31:
  s_mov_b64 exec, -1
  s_mov_b32 s82, 0
FF_29:
  v_mov_b32 v6, 0
L_XRP:
  ds_read_b128 v[8:11], v6
  ds_read_b128 v[12:15], v6 offset:16
  s_waitcnt lgkmcnt(0)
  v_min3_u32 v8, v8, v9, v10
  v_min3_u32 v11, v11, v12, v13
  v_min3_u32 v8, v8, v14, v15
  v_min_u32 v8, v8, v11
  v_cmp_gt_u32 vcc, s85, v8
  s_cbranch_vccz L_XRPK
  s_add_u32 s67, s67, 1
  s_cmp_lt_u32 s67, 524288
  s_cbranch_scc1 L_XRP
  s_branch L_END
L_XRPK:
  ds_read_b128 v[8:11], v1 offset:1024
  ds_read_b128 v[12:15], v1 offset:2048
  s_and_b32 s30, s81, 1
  s_mul_i32 s30, s30, 49152
  v_add_u32 v6, s30, v7
  s_and_b32 s31, s81, s20
  s_lshl_b32 s31, s31, 18
  s_add_u32 s31, s31, s79
  s_add_u32 s30, s31, 4096
  ds_read_b128 v[16:19], v6 offset:0
  ds_read_b128 v[20:23], v6 offset:1024
  ds_read_b128 v[24:27], v6 offset:2048
  ds_read_b128 v[28:31], v6 offset:3072
  s_waitcnt lgkmcnt(3)
  v_mfma_f32_16x16x32_bf16 v[32:35], v[8:11], v[16:19], 0
  s_waitcnt lgkmcnt(2)
  v_mfma_f32_16x16x32_bf16 v[32:35], v[8:11], v[20:23], v[32:35]
  s_waitcnt lgkmcnt(1)
  v_mfma_f32_16x16x32_bf16 v[32:35], v[12:15], v[24:27], v[32:35]
  s_waitcnt lgkmcnt(0)
  v_mfma_f32_16x16x32_bf16 v[32:35], v[12:15], v[28:31], v[32:35]
  ds_read_b128 v[16:19], v6 offset:24576
  ds_read_b128 v[20:23], v6 offset:25600
  ds_read_b128 v[24:27], v6 offset:26624
  ds_read_b128 v[28:31], v6 offset:27648
  s_waitcnt lgkmcnt(3)
  v_mfma_f32_16x16x32_bf16 v[36:39], v[8:11], v[16:19], 0
  s_waitcnt lgkmcnt(2)
  v_mfma_f32_16x16x32_bf16 v[36:39], v[8:11], v[20:23], v[36:39]
  s_waitcnt lgkmcnt(1)
  v_mfma_f32_16x16x32_bf16 v[36:39], v[12:15], v[24:27], v[36:39]
  s_waitcnt lgkmcnt(0)
  v_mfma_f32_16x16x32_bf16 v[36:39], v[12:15], v[28:31], v[36:39]
  s_nop 7
  v_cvt_pk_bf16_f32 v32, v32, v33
  v_cvt_pk_bf16_f32 v33, v34, v35
  v_cvt_pk_bf16_f32 v36, v36, v37
  v_cvt_pk_bf16_f32 v37, v38, v39
  s_cmp_eq_u32 s27, 0
  s_cbranch_scc0 LS_32
  buffer_store_dwordx2 v[32:33], v4, s[4:7], s31 offen
  buffer_store_dwordx2 v[36:37], v4, s[4:7], s30 offen
LD_33:
  s_mov_b32 s82, s85
  s_cmp_ge_u32 s81, 5
  s_cbranch_scc1 L_XRS
  s_cmp_eq_u32 s82, 0
  s_cbranch_scc1 FF_34
  s_waitcnt vmcnt(0)
  s_mov_b64 exec, 1
  v_mov_b32 v8, 0
  v_mov_b32 v9, s82
  s_cmp_eq_u32 s27, 0
  s_cbranch_scc0 LS_35
  buffer_store_dword v9, v8, s[4:7], s83 offen
LD_36:
  s_mov_b64 exec, -1
  s_mov_b32 s82, 0
FF_34:
L_XRS:
  ds_write_b32 v3, v5 offset:128
  s_add_u32 s81, s81, 1
  s_branch L_XP
L_PT:
  s_waitcnt vmcnt(0)
  s_cmp_eq_u32 s82, 0
  s_cbranch_scc1 FF_37
  s_mov_b64 exec, 1
  v_mov_b32 v8, 0
  v_mov_b32 v9, s82
  s_cmp_eq_u32 s27, 0
  s_cbranch_scc0 LS_38
  buffer_store_dword v9, v8, s[4:7], s83 offen
LD_39:
  s_mov_b64 exec, -1
  s_mov_b32 s82, 0
FF_37:
  s_mul_i32 s30, s25, 384
  s_lshl_b32 s31, s64, 5
  s_add_u32 s30, s30, s31
  s_add_u32 s30, s30, 1572864
  v_and_b32 v8, 7, v0
  v_lshlrev_b32 v8, 2, v8
  v_and_b32 v9, 8, v0
  v_lshlrev_b32 v9, 4, v9
  v_add_u32 v8, v8, v9
L_PQ:
  buffer_load_dword v9, v8, s[4:7], s30 offen sc1
  s_waitcnt vmcnt(0)
  v_cmp_ge_u32 vcc, s80, v9
  s_cbranch_vccz L_PQK
  s_add_u32 s67, s67, 1
  s_cmp_lt_u32 s67, 524288
  s_cbranch_scc1 L_PQ
  s_branch L_END
L_PQK:
  s_and_b32 s65, s80, s20
  s_lshl_b32 s65, s65, 5
  s_lshl_b32 s30, s25, 2
  s_add_u32 s65, s65, s30
  s_add_u32 s65, s65, s64
  s_lshl_b32 s66, s65, 12
  s_add_u32 s66, s66, 16777216
  s_lshl_b32 s30, s88, 11
  s_add_u32 s66, s66, s30
  s_lshl_b32 s65, s65, 13
  s_lshl_b32 s30, s88, 12
  s_add_u32 s30, s30, s65
  s_add_u32 s30, s30, 33554432
  buffer_load_dwordx4 v[136:139], v1, s[4:7], s30 offen offset:0 sc1
  buffer_load_dwordx4 v[140:143], v1, s[4:7], s30 offen offset:1024 sc1
  buffer_load_dwordx4 v[144:147], v1, s[4:7], s30 offen offset:2048 sc1
  buffer_load_dwordx4 v[148:151], v1, s[4:7], s30 offen offset:3072 sc1
  s_add_u32 s30, s65, 50331648
  buffer_load_dwordx4 v[152:155], v1, s[4:7], s30 offen offset:0 sc1
  buffer_load_dwordx4 v[156:159], v1, s[4:7], s30 offen offset:1024 sc1
  buffer_load_dwordx4 v[160:163], v1, s[4:7], s30 offen offset:2048 sc1
  buffer_load_dwordx4 v[164:167], v1, s[4:7], s30 offen offset:3072 sc1
  s_add_u32 s30, s65, 83886080
  v_or_b32 v5, 128, v1
  buffer_load_dwordx4 v[28:31], v5, s[4:7], s30 offen offset:0 sc1
  buffer_load_dwordx4 v[32:35], v5, s[4:7], s30 offen offset:1024 sc1
  buffer_load_dwordx4 v[36:39], v5, s[4:7], s30 offen offset:2048 sc1
  buffer_load_dwordx4 v[8:11], v5, s[4:7], s30 offen offset:3072 sc1
  v_mov_b32 v16, 0
  v_mov_b32 v17, 0
  v_mov_b32 v18, 0
  v_mov_b32 v19, 0
  s_mov_b64 exec, s[92:93]
  v_mov_b32 v16, 0xf149f2ca
  v_mov_b32 v17, 0xf149f2ca
  v_mov_b32 v18, 0xf149f2ca
  v_mov_b32 v19, 0xf149f2ca
  s_mov_b64 exec, -1
  v_lshrrev_b32 v15, 4, v0
  v_lshlrev_b32 v15, 2, v15
  v_and_b32 v6, 15, v0
  v_sub_u32 v6, v6, v15
  v_mov_b32 v15, 0xf149f2ca
  s_cmp_eq_u32 s88, 1
  s_cbranch_scc1 L_PT1
  v_cmp_gt_i32 vcc, 0, v6
  v_mov_b32 v24, v15
  s_nop 0
  v_cndmask_b32 v20, 0, v15, vcc
  v_cmp_gt_i32 vcc, 1, v6
  v_mov_b32 v25, v15
  s_nop 0
  v_cndmask_b32 v21, 0, v15, vcc
  v_cmp_gt_i32 vcc, 2, v6
  v_mov_b32 v26, v15
  s_nop 0
  v_cndmask_b32 v22, 0, v15, vcc
  v_cmp_gt_i32 vcc, 3, v6
  v_mov_b32 v27, v15
  s_nop 0
  v_cndmask_b32 v23, 0, v15, vcc
  s_branch L_PT2
L_PT1:
  v_cmp_gt_i32 vcc, 0, v6
  v_mov_b32 v20, 0
  s_nop 0
  v_cndmask_b32 v24, 0, v15, vcc
  v_cmp_gt_i32 vcc, 1, v6
  v_mov_b32 v21, 0
  s_nop 0
  v_cndmask_b32 v25, 0, v15, vcc
  v_cmp_gt_i32 vcc, 2, v6
  v_mov_b32 v22, 0
  s_nop 0
  v_cndmask_b32 v26, 0, v15, vcc
  v_cmp_gt_i32 vcc, 3, v6
  v_mov_b32 v23, 0
  s_nop 0
  v_cndmask_b32 v27, 0, v15, vcc
L_PT2:
  s_waitcnt vmcnt(0)
  v_mfma_f32_16x16x32_bf16 v[16:19], v[28:31], v[136:139], v[16:19]
  v_mfma_f32_16x16x32_bf16 v[20:23], v[152:155], v[136:139], v[20:23]
  v_mfma_f32_16x16x32_bf16 v[16:19], v[32:35], v[140:143], v[16:19]
  v_mfma_f32_16x16x32_bf16 v[20:23], v[156:159], v[140:143], v[20:23]
  v_mfma_f32_16x16x32_bf16 v[16:19], v[36:39], v[144:147], v[16:19]
  v_mfma_f32_16x16x32_bf16 v[20:23], v[160:163], v[144:147], v[20:23]
  v_mfma_f32_16x16x32_bf16 v[16:19], v[8:11], v[148:151], v[16:19]
  v_mfma_f32_16x16x32_bf16 v[20:23], v[164:167], v[148:151], v[20:23]
  s_cmp_eq_u32 s88, 0
  s_cbranch_scc1 L_PT3
  s_add_u32 s30, s65, 50335744
  buffer_load_dwordx4 v[152:155], v1, s[4:7], s30 offen offset:0 sc1
  buffer_load_dwordx4 v[156:159], v1, s[4:7], s30 offen offset:1024 sc1
  buffer_load_dwordx4 v[160:163], v1, s[4:7], s30 offen offset:2048 sc1
  buffer_load_dwordx4 v[164:167], v1, s[4:7], s30 offen offset:3072 sc1
  s_waitcnt vmcnt(0)
  v_mfma_f32_16x16x32_bf16 v[24:27], v[152:155], v[136:139], v[24:27]
  v_mfma_f32_16x16x32_bf16 v[24:27], v[156:159], v[140:143], v[24:27]
  v_mfma_f32_16x16x32_bf16 v[24:27], v[160:163], v[144:147], v[24:27]
  v_mfma_f32_16x16x32_bf16 v[24:27], v[164:167], v[148:151], v[24:27]
L_PT3:
  s_nop 7
  v_max3_f32 v8, v16, v17, v18
  v_max3_f32 v9, v19, v20, v21
  v_max3_f32 v8, v8, v22, v23
  v_max3_f32 v9, v9, v24, v25
  v_max3_f32 v8, v8, v26, v27
  v_max_f32 v8, v8, v9
  v_mov_b32 v9, v8
  s_nop 1
  v_permlane32_swap_b32 v8, v9
  s_nop 1
  v_max_f32 v8, v8, v9
  v_mov_b32 v9, v8
  s_nop 1
  v_permlane16_swap_b32 v8, v9
  s_nop 1
  v_max_f32 v8, v8, v9
  v_mul_f32 v8, s84, v8
  v_fma_f32 v16, v16, s84, -v8
  v_fma_f32 v17, v17, s84, -v8
  v_fma_f32 v18, v18, s84, -v8
  v_fma_f32 v19, v19, s84, -v8
  v_fma_f32 v20, v20, s84, -v8
  v_fma_f32 v21, v21, s84, -v8
  v_fma_f32 v22, v22, s84, -v8
  v_fma_f32 v23, v23, s84, -v8
  v_fma_f32 v24, v24, s84, -v8
  v_fma_f32 v25, v25, s84, -v8
  v_fma_f32 v26, v26, s84, -v8
  v_fma_f32 v27, v27, s84, -v8
  v_exp_f32 v16, v16
  v_exp_f32 v17, v17
  v_exp_f32 v18, v18
  v_exp_f32 v19, v19
  v_exp_f32 v20, v20
  v_exp_f32 v21, v21
  v_exp_f32 v22, v22
  v_exp_f32 v23, v23
  v_exp_f32 v24, v24
  v_exp_f32 v25, v25
  v_exp_f32 v26, v26
  v_exp_f32 v27, v27
  s_nop 0
  v_add_f32 v8, v16, v17
  v_add_f32 v8, v8, v18
  v_add_f32 v8, v8, v19
  v_add_f32 v8, v8, v20
  v_add_f32 v8, v8, v21
  v_add_f32 v8, v8, v22
  v_add_f32 v8, v8, v23
  v_add_f32 v8, v8, v24
  v_add_f32 v8, v8, v25
  v_add_f32 v8, v8, v26
  v_add_f32 v8, v8, v27
  v_mov_b32 v9, v8
  s_nop 1
  v_permlane32_swap_b32 v8, v9
  s_nop 1
  v_add_f32 v8, v8, v9
  v_mov_b32 v9, v8
  s_nop 1
  v_permlane16_swap_b32 v8, v9
  s_nop 1
  v_add_f32 v8, v8, v9
  v_rcp_f32 v8, v8
  s_nop 0
  v_mul_f32 v16, v16, v8
  v_mul_f32 v17, v17, v8
  v_mul_f32 v18, v18, v8
  v_mul_f32 v19, v19, v8
  v_mul_f32 v20, v20, v8
  v_mul_f32 v21, v21, v8
  v_mul_f32 v22, v22, v8
  v_mul_f32 v23, v23, v8
  v_mul_f32 v24, v24, v8
  v_mul_f32 v25, v25, v8
  v_mul_f32 v26, v26, v8
  v_mul_f32 v27, v27, v8
  v_cvt_pk_bf16_f32 v28, v20, v21
  v_cvt_pk_bf16_f32 v29, v22, v23
  v_cvt_pk_bf16_f32 v30, v24, v25
  v_cvt_pk_bf16_f32 v31, v26, v27
  v_cvt_pk_bf16_f32 v32, v16, v17
  v_cvt_pk_bf16_f32 v33, v18, v19
  v_cvt_pk_bf16_f32 v34, v16, v17
  v_cvt_pk_bf16_f32 v35, v18, v19
  s_nop 1
  v_permlane32_swap_b32 v34, v32
  v_permlane32_swap_b32 v35, v33
  v_lshrrev_b32 v8, 1, v1
  s_nop 1
  s_cmp_eq_u32 s27, 0
  s_cbranch_scc0 LS_40
  buffer_store_dwordx4 v[28:31], v1, s[4:7], s66 offen
  buffer_store_dwordx2 v[32:33], v8, s[4:7], s66 offen offset:1024
LD_41:
  s_sub_u32 s78, s78, 65536
  s_sub_u32 s87, s87, 65536
  buffer_load_dwordx4 v[136:139], v1, s[4:7], s78 offen offset:0
  buffer_load_dwordx4 v[140:143], v1, s[4:7], s78 offen offset:1024
  buffer_load_dwordx4 v[144:147], v1, s[4:7], s78 offen offset:2048
  buffer_load_dwordx4 v[148:151], v1, s[4:7], s78 offen offset:3072
  buffer_load_dwordx4 v[152:155], v1, s[4:7], s87 offen offset:0
  buffer_load_dwordx4 v[156:159], v1, s[4:7], s87 offen offset:1024
  buffer_load_dwordx4 v[160:163], v1, s[4:7], s87 offen offset:2048
  buffer_load_dwordx4 v[164:167], v1, s[4:7], s87 offen offset:3072
  s_add_u32 s78, s78, 65536
  s_add_u32 s87, s87, 65536
  s_waitcnt vmcnt(8)
  s_lshl_b32 s30, s25, 2
  s_add_u32 s30, s30, s64
  s_lshl_b32 s30, s30, 6
  s_add_u32 s30, s30, s80
  s_lshl_b32 s30, s30, 1
  s_add_u32 s30, s30, s88
  s_lshl_b32 s30, s30, 2
  s_add_u32 s30, s30, 1576960
  s_add_u32 s31, s80, 1
  s_mov_b64 exec, 1
  v_mov_b32 v8, s31
  v_mov_b32 v9, 0
  s_cmp_eq_u32 s27, 0
  s_cbranch_scc0 LS_42
  buffer_store_dword v8, v9, s[4:7], s30 offen
LD_43:
  s_mov_b64 exec, -1
  s_add_u32 s80, s80, 16
  s_branch L_XP
L_XP_DONE:
  s_waitcnt vmcnt(0) lgkmcnt(0)
  s_endpgm
L_BV:
  s_setprio 1
  s_mov_b32 s30, 1609728
  v_lshlrev_b32 v8, 2, v0
L_T2FB:
  buffer_load_dword v9, v8, s[4:7], s30 offen offset:0 sc1
  buffer_load_dword v10, v8, s[4:7], s30 offen offset:256 sc1
  buffer_load_dword v11, v8, s[4:7], s30 offen offset:512 sc1
  buffer_load_dword v12, v8, s[4:7], s30 offen offset:768 sc1
  s_waitcnt vmcnt(0)
  v_min3_u32 v9, v9, v10, v11
  v_min_u32 v9, v9, v12
  v_cmp_eq_u32 vcc, 0, v9
  s_cbranch_vccz L_T2KB
  s_add_u32 s67, s67, 1
  s_cmp_lt_u32 s67, 524288
  s_cbranch_scc1 L_T2FB
  s_branch L_END
L_T2KB:
  s_mov_b32 s30, 8404992
  s_mov_b32 s31, 0
  v_mov_b32 v8, 0
  v_mov_b32 v9, 0
L_T2LB:
  buffer_load_dwordx4 v[16:19], v1, s[4:7], s30 offen offset:0 sc1
  buffer_load_dwordx4 v[20:23], v1, s[4:7], s30 offen offset:1024 sc1
  buffer_load_dwordx4 v[24:27], v1, s[4:7], s30 offen offset:2048 sc1
  buffer_load_dwordx4 v[28:31], v1, s[4:7], s30 offen offset:3072 sc1
  s_waitcnt vmcnt(0)
  v_med3_u32 v9, v8, v9, v16
  v_max_u32 v8, v8, v16
  v_med3_u32 v9, v8, v9, v17
  v_max_u32 v8, v8, v17
  v_med3_u32 v9, v8, v9, v18
  v_max_u32 v8, v8, v18
  v_med3_u32 v9, v8, v9, v19
  v_max_u32 v8, v8, v19
  v_med3_u32 v9, v8, v9, v20
  v_max_u32 v8, v8, v20
  v_med3_u32 v9, v8, v9, v21
  v_max_u32 v8, v8, v21
  v_med3_u32 v9, v8, v9, v22
  v_max_u32 v8, v8, v22
  v_med3_u32 v9, v8, v9, v23
  v_max_u32 v8, v8, v23
  v_med3_u32 v9, v8, v9, v24
  v_max_u32 v8, v8, v24
  v_med3_u32 v9, v8, v9, v25
  v_max_u32 v8, v8, v25
  v_med3_u32 v9, v8, v9, v26
  v_max_u32 v8, v8, v26
  v_med3_u32 v9, v8, v9, v27
  v_max_u32 v8, v8, v27
  v_med3_u32 v9, v8, v9, v28
  v_max_u32 v8, v8, v28
  v_med3_u32 v9, v8, v9, v29
  v_max_u32 v8, v8, v29
  v_med3_u32 v9, v8, v9, v30
  v_max_u32 v8, v8, v30
  v_med3_u32 v9, v8, v9, v31
  v_max_u32 v8, v8, v31
  s_add_u32 s30, s30, 4096
  s_add_u32 s31, s31, 1
  s_cmp_lt_u32 s31, 2
  s_cbranch_scc1 L_T2LB
  v_mov_b32 v10, v8
  s_nop 1
  v_max_u32_dpp v10, v10, v10 row_ror:8 row_mask:0xf bank_mask:0xf
  s_nop 1
  v_max_u32_dpp v10, v10, v10 row_ror:4 row_mask:0xf bank_mask:0xf
  s_nop 1
  v_max_u32_dpp v10, v10, v10 row_ror:2 row_mask:0xf bank_mask:0xf
  s_nop 1
  v_max_u32_dpp v10, v10, v10 row_ror:1 row_mask:0xf bank_mask:0xf
  v_mov_b32 v11, v10
  s_nop 1
  v_permlane16_swap_b32 v10, v11
  s_nop 1
  v_max_u32 v10, v10, v11
  v_mov_b32 v11, v10
  s_nop 1
  v_permlane32_swap_b32 v10, v11
  s_nop 1
  v_max_u32 v10, v10, v11
  v_cmp_eq_u32 vcc, v8, v10
  s_nop 1
  v_cndmask_b32 v8, v8, v9, vcc
  s_nop 1
  v_max_u32_dpp v8, v8, v8 row_ror:8 row_mask:0xf bank_mask:0xf
  s_nop 1
  v_max_u32_dpp v8, v8, v8 row_ror:4 row_mask:0xf bank_mask:0xf
  s_nop 1
  v_max_u32_dpp v8, v8, v8 row_ror:2 row_mask:0xf bank_mask:0xf
  s_nop 1
  v_max_u32_dpp v8, v8, v8 row_ror:1 row_mask:0xf bank_mask:0xf
  v_mov_b32 v11, v8
  s_nop 1
  v_permlane16_swap_b32 v8, v11
  s_nop 1
  v_max_u32 v8, v8, v11
  v_mov_b32 v11, v8
  s_nop 1
  v_permlane32_swap_b32 v8, v11
  s_nop 1
  v_max_u32 v8, v8, v11
  v_readfirstlane_b32 s76, v10
  v_readfirstlane_b32 s77, v8
  s_and_b32 s76, s76, 0xffff
  s_sub_u32 s76, 0xffff, s76
  s_and_b32 s76, s76, 2047
  s_and_b32 s77, s77, 0xffff
  s_sub_u32 s77, 0xffff, s77
  s_and_b32 s77, s77, 2047
  v_mov_b32 v8, s76
  v_mov_b32 v9, s77
  v_mov_b32 v10, 1
  v_mov_b32 v11, 1
  v_mov_b32 v5, 192
  ds_write_b128 v5, v[8:11]
  s_mov_b32 s62, s76
  s_mov_b32 s63, s77
  s_lshr_b32 s76, s76, 5
  s_lshr_b32 s77, s77, 5
  s_lshl_b32 s30, s64, 2
  s_add_u32 s30, s30, 0
  v_mov_b32 v2, s30
  v_and_b32 v7, 7, v0
  v_lshlrev_b32 v7, 4, v7
  v_bfe_u32 v9, v0, 4, 1
  v_lshl_add_u32 v7, v9, 3, v7
  v_lshrrev_b32 v9, 5, v0
  v_lshl_add_u32 v7, v9, 17, v7
  v_bfe_u32 v10, v0, 3, 1
  v_lshl_add_u32 v7, v10, 16, v7
  v_lshlrev_b32 v14, 10, v9
  v_and_b32 v10, 31, v0
  v_lshl_add_u32 v14, v10, 3, v14
  s_lshl_b32 s30, s64, 8
  s_add_u32 s30, s30, 101376
  v_add_u32 v14, s30, v14
  v_lshrrev_b32 v9, 4, v0
  v_lshlrev_b32 v12, 11, v9
  v_and_b32 v8, 7, v0
  v_lshlrev_b32 v10, 2, v8
  v_add_u32 v12, v12, v10
  v_lshlrev_b32 v13, 2, v9
  v_lshrrev_b32 v9, 3, v0
  v_lshlrev_b32 v15, 9, v9
  v_lshlrev_b32 v8, 4, v8
  v_add_u32 v15, v15, v8
  s_lshl_b32 s30, s64, 7
  v_add_u32 v15, s30, v15
  v_mov_b32 v3, 1572864
  v_lshlrev_b32 v8, 2, v0
  s_mul_i32 s30, s25, 384
  s_lshl_b32 s31, s64, 5
  s_add_u32 s30, s30, s31
  s_add_u32 s30, s30, 1573120
  s_mov_b64 exec, 0xff
  v_add_u32 v3, s30, v8
  s_lshl_b32 s30, s25, 8
  s_lshl_b32 s31, s64, 6
  s_add_u32 s30, s30, s31
  s_add_u32 s30, s30, 1613824
  s_mov_b64 exec, 0xff00
  v_bfe_u32 v9, v0, 1, 2
  v_lshlrev_b32 v9, 4, v9
  v_and_b32 v10, 1, v0
  v_lshl_add_u32 v9, v10, 2, v9
  v_add_u32 v3, s30, v9
  s_add_u32 s30, s30, 8
  s_mov_b64 exec, 0xff0000
  v_bfe_u32 v9, v0, 1, 2
  v_lshlrev_b32 v9, 4, v9
  v_and_b32 v10, 1, v0
  v_lshl_add_u32 v9, v10, 2, v9
  v_add_u32 v3, s30, v9
  s_lshl_b32 s30, s25, 11
  s_lshl_b32 s31, s64, 9
  s_add_u32 s30, s30, s31
  s_add_u32 s30, s30, 1576864
  s_mov_b64 exec, 0x3000000
  v_add_u32 v3, s30, v8
  s_lshr_b32 s30, s25, 1
  s_lshl_b32 s30, s30, 2
  s_add_u32 s30, s30, 1609728
  s_mov_b64 exec, 0x4000000
  v_mov_b32 v3, s30
  s_lshl_b32 s30, s25, 4
  s_add_u32 s30, s30, s71
  s_lshl_b32 s30, s30, 7
  s_lshr_b32 s31, s25, 2
  s_lshl_b32 s31, s31, 3
  s_add_u32 s30, s30, s31
  s_add_u32 s30, s30, 1593344
  s_mov_b32 exec_lo, 0
  s_mov_b32 exec_hi, 0xffff
  v_bfe_u32 v9, v0, 1, 3
  v_lshlrev_b32 v9, 4, v9
  v_and_b32 v10, 1, v0
  v_lshlrev_b32 v10, 2, v10
  v_add_u32 v9, v9, v10
  v_add_u32 v3, s30, v9
  s_mov_b64 exec, -1
  s_lshl_b32 s78, s25, 2
  s_add_u32 s78, s78, s64
  s_lshl_b32 s88, s78, 12
  s_add_u32 s88, s88, 16777216
  s_lshl_b32 s78, s78, 13
  s_lshl_b32 s79, s25, 4
  s_add_u32 s79, s79, s71
  s_lshl_b32 s81, s79, 12
  s_add_u32 s81, s81, 100663296
  s_lshl_b32 s79, s79, 2
  s_add_u32 s79, s79, s64
  s_lshl_b32 s85, s79, 2
  s_add_u32 s85, s85, 1617920
  s_lshl_b32 s79, s79, 12
  s_add_u32 s79, s79, 167772160
  s_lshr_b32 s30, s64, 1
  s_lshl_b32 s30, s30, 6
  s_add_u32 s30, s30, s71
  s_lshl_b32 s80, s30, 12
  s_lshl_b32 s84, s30, 7
  s_lshl_b32 s31, s25, 9
  s_add_u32 s80, s80, s31
  s_and_b32 s31, s64, 1
  s_lshl_b32 s31, s31, 8
  s_add_u32 s80, s80, s31
  s_add_u32 s80, s80, 100663296
  s_lshl_b32 s31, s25, 4
  s_add_u32 s84, s84, s31
  s_lshl_b32 s31, s64, 2
  s_add_u32 s84, s84, s31
  s_add_u32 s84, s84, 1593344
  s_lshl_b32 s82, s25, 13
  s_lshl_b32 s30, s71, 7
  s_add_u32 s82, s82, s30
  s_lshl_b32 s30, s64, 5
  s_add_u32 s82, s82, s30
  s_lshl_b32 s83, s25, 4
  s_add_u32 s83, s83, 8388608
  s_mov_b32 s28, 0
  s_mov_b32 s29, 0
  s_mov_b32 s100, 0
  s_mov_b32 s101, 0
  s_mov_b32 s75, 0
  s_mov_b32 s99, 0
  v_mov_b32 v5, v3
  v_mov_b32 v4, 0
  s_add_u32 s30, s28, 1
  s_mov_b64 exec, 0xff
  v_mov_b32 v4, s30
  s_add_u32 s30, s101, 1
  s_mov_b64 exec, 0xff00
  v_mov_b32 v4, s30
  s_add_u32 s30, s29, 1
  s_mov_b64 exec, 0x3ff0000
  v_mov_b32 v4, s30
  s_min_u32 s30, s29, 63
  s_lshl_b32 s30, s30, 3
  s_mov_b64 exec, 0x3000000
  v_add_u32 v5, s30, v3
  s_min_u32 s30, s100, 63
  s_lshl_b32 s30, s30, 4
  s_mov_b64 exec, 0x4000000
  v_add_u32 v5, s30, v3
  s_add_u32 s30, s100, 1
  s_mov_b32 exec_hi, 0xffff
  v_mov_b32 v4, s30
  s_mov_b64 exec, -1
  buffer_load_dword v6, v5, s[4:7], 0 offen sc1
  s_waitcnt vmcnt(0)
L_BV_LOOP:
  v_cmp_lt_u32 vcc, v6, v4
  s_mov_b32 s72, 0
  s_mov_b32 s73, 0
  s_mov_b32 s74, 0
  v_mov_b32 v9, v6
  s_nop 1
  v_min_u32_dpp v9, v9, v9 row_shl:4 row_mask:0xf bank_mask:0xf
  s_nop 1
  v_min_u32_dpp v9, v9, v9 row_shl:2 row_mask:0xf bank_mask:0xf
  s_nop 1
  v_min_u32_dpp v9, v9, v9 row_shl:1 row_mask:0xf bank_mask:0xf
  s_nop 1
  v_readlane_b32 s30, v9, 8
  s_cmp_le_u32 s30, s101
  s_cbranch_scc1 L_D0
  s_mov_b32 s101, s30
  v_mov_b32 v9, s101
  ds_write_b32 v2, v9 offset:64
L_D0:
  s_and_b32 s30, vcc_lo, 0xff
  s_cmp_lg_u32 s30, 0
  s_cbranch_scc1 L_D1
  s_add_u32 s30, s29, 8
  s_add_u32 s31, s101, 7
  s_min_u32 s30, s30, s31
  s_cmp_ge_u32 s28, s30
  s_cbranch_scc1 L_D1
  s_mov_b32 s72, 1
L_D1:
  s_and_b32 s30, vcc_lo, 0x3ff0000
  s_cmp_lg_u32 s30, 0
  s_cbranch_scc1 L_D2
  s_cmp_ge_u32 s29, s28
  s_cbranch_scc1 L_D2
  s_add_u32 s30, s99, 1
  s_cmp_lt_u32 s30, s29
  s_cbranch_scc1 L_D2
  s_mov_b32 s73, 1
L_D2:
  s_and_b32 s30, vcc_lo, 0x4000000
  s_and_b32 s31, vcc_hi, 0xffff
  s_or_b32 s30, s30, s31
  s_cmp_lg_u32 s30, 0
  s_cbranch_scc1 L_D3
  s_mov_b32 s74, 1
L_D3:
  s_add_u32 s30, s72, s73
  s_add_u32 s30, s30, s74
  s_cmp_eq_u32 s30, 3
  s_cselect_b32 s89, 1, 0
  s_cmp_lg_u32 s30, 0
  s_cbranch_scc1 L_BVGO
  s_waitcnt vmcnt(0)
  s_cmp_eq_u32 s75, 0
  s_cbranch_scc1 F3_44
  s_mov_b64 exec, 0xf
  v_mov_b32 v9, s75
  v_lshlrev_b32 v10, 7, v1
  buffer_store_dword v9, v10, s[4:7], s84 offen sc1
  s_mov_b64 exec, -1
  s_mov_b32 s75, 0
F3_44:
  s_cmp_ge_u32 s100, 64
  s_cbranch_scc1 L_BVEND
  s_cmp_ge_u32 s101, 62
  s_cbranch_scc1 L_BVQ
  s_sleep 2
L_BVQ:
  v_mov_b32 v5, v3
  v_mov_b32 v4, 0
  s_add_u32 s30, s28, 1
  s_mov_b64 exec, 0xff
  v_mov_b32 v4, s30
  s_add_u32 s30, s101, 1
  s_mov_b64 exec, 0xff00
  v_mov_b32 v4, s30
  s_add_u32 s30, s29, 1
  s_mov_b64 exec, 0x3ff0000
  v_mov_b32 v4, s30
  s_min_u32 s30, s29, 63
  s_lshl_b32 s30, s30, 3
  s_mov_b64 exec, 0x3000000
  v_add_u32 v5, s30, v3
  s_min_u32 s30, s100, 63
  s_lshl_b32 s30, s30, 4
  s_mov_b64 exec, 0x4000000
  v_add_u32 v5, s30, v3
  s_add_u32 s30, s100, 1
  s_mov_b32 exec_hi, 0xffff
  v_mov_b32 v4, s30
  s_mov_b64 exec, -1
  buffer_load_dword v6, v5, s[4:7], 0 offen sc1
  s_add_u32 s67, s67, 1
  s_cmp_lt_u32 s67, 524288
  s_cbranch_scc1 L_TRYRED
  s_branch L_END
L_BVGO:
  s_cmp_eq_u32 s72, 0
  s_cbranch_scc1 L_BV1
  s_and_b32 s30, s28, s20
  s_lshl_b32 s30, s30, 18
  s_add_u32 s30, s30, s78
  s_add_u32 s30, s30, 67108864
  s_add_u32 s31, s30, 4096
  buffer_load_dwordx4 v[16:19], v1, s[4:7], s30 offen offset:0 sc1
  buffer_load_dwordx4 v[20:23], v1, s[4:7], s30 offen offset:1024 sc1
  buffer_load_dwordx4 v[24:27], v1, s[4:7], s30 offen offset:2048 sc1
  buffer_load_dwordx4 v[28:31], v1, s[4:7], s30 offen offset:3072 sc1
  buffer_load_dwordx4 v[32:35], v1, s[4:7], s31 offen offset:0 sc1
  buffer_load_dwordx4 v[36:39], v1, s[4:7], s31 offen offset:1024 sc1
  buffer_load_dwordx4 v[40:43], v1, s[4:7], s31 offen offset:2048 sc1
  buffer_load_dwordx4 v[44:47], v1, s[4:7], s31 offen offset:3072 sc1
L_BV1:
  s_cmp_eq_u32 s73, 0
  s_cbranch_scc1 L_BV3
  s_and_b32 s30, s29, s20
  s_lshl_b32 s30, s30, 18
  s_add_u32 s30, s30, s78
  s_add_u32 s30, s30, 83890176
  buffer_load_dwordx4 v[80:83], v1, s[4:7], s30 offen sc1
  buffer_load_dwordx4 v[84:87], v1, s[4:7], s30 offen offset:1024 sc1
L_BV3:
  s_cmp_eq_u32 s74, 0
  s_cbranch_scc1 L_BV2
  s_lshl_b32 s30, s100, 19
  s_add_u32 s30, s30, s81
  buffer_load_dwordx4 v[92:95], v15, s[4:7], s30 offen sc1
  s_lshl_b32 s30, s100, 16
  s_add_u32 s87, s30, s82
  buffer_load_dword v88, v12, s[8:11], s87 offen
  s_lshl_b32 s30, s100, 7
  s_add_u32 s30, s30, s83
  buffer_load_dword v90, v13, s[4:7], s30 offen sc1
L_BV2:
  s_cmp_eq_u32 s72, 0
  s_cbranch_scc1 L_BV4a
  s_waitcnt vmcnt(5)
  s_cmp_eq_u32 s89, 1
  s_cbranch_scc1 WV_45
  s_waitcnt vmcnt(0)
WV_45:
  v_mfma_f32_16x16x32_bf16 v[48:51], v[16:19], v[104:107], 0
  v_mfma_f32_16x16x32_bf16 v[52:55], v[16:19], v[108:111], 0
  v_mfma_f32_16x16x32_bf16 v[56:59], v[16:19], v[112:115], 0
  v_mfma_f32_16x16x32_bf16 v[60:63], v[16:19], v[116:119], 0
  v_mfma_f32_16x16x32_bf16 v[64:67], v[32:35], v[104:107], 0
  v_mfma_f32_16x16x32_bf16 v[68:71], v[32:35], v[108:111], 0
  v_mfma_f32_16x16x32_bf16 v[72:75], v[32:35], v[112:115], 0
  v_mfma_f32_16x16x32_bf16 v[76:79], v[32:35], v[116:119], 0
  v_mfma_f32_16x16x32_bf16 v[48:51], v[20:23], v[120:123], v[48:51]
  v_mfma_f32_16x16x32_bf16 v[52:55], v[20:23], v[124:127], v[52:55]
  v_mfma_f32_16x16x32_bf16 v[56:59], v[20:23], v[128:131], v[56:59]
  v_mfma_f32_16x16x32_bf16 v[60:63], v[20:23], v[132:135], v[60:63]
  v_mfma_f32_16x16x32_bf16 v[64:67], v[36:39], v[120:123], v[64:67]
  v_mfma_f32_16x16x32_bf16 v[68:71], v[36:39], v[124:127], v[68:71]
  v_mfma_f32_16x16x32_bf16 v[72:75], v[36:39], v[128:131], v[72:75]
  v_mfma_f32_16x16x32_bf16 v[76:79], v[36:39], v[132:135], v[76:79]
  v_mfma_f32_16x16x32_bf16 v[48:51], v[24:27], v[136:139], v[48:51]
  v_mfma_f32_16x16x32_bf16 v[52:55], v[24:27], v[140:143], v[52:55]
  v_mfma_f32_16x16x32_bf16 v[56:59], v[24:27], v[144:147], v[56:59]
  v_mfma_f32_16x16x32_bf16 v[60:63], v[24:27], v[148:151], v[60:63]
  v_mfma_f32_16x16x32_bf16 v[64:67], v[40:43], v[136:139], v[64:67]
  v_mfma_f32_16x16x32_bf16 v[68:71], v[40:43], v[140:143], v[68:71]
  v_mfma_f32_16x16x32_bf16 v[72:75], v[40:43], v[144:147], v[72:75]
  v_mfma_f32_16x16x32_bf16 v[76:79], v[40:43], v[148:151], v[76:79]
  v_mfma_f32_16x16x32_bf16 v[48:51], v[28:31], v[152:155], v[48:51]
  v_mfma_f32_16x16x32_bf16 v[52:55], v[28:31], v[156:159], v[52:55]
  v_mfma_f32_16x16x32_bf16 v[56:59], v[28:31], v[160:163], v[56:59]
  v_mfma_f32_16x16x32_bf16 v[60:63], v[28:31], v[164:167], v[60:63]
  v_mfma_f32_16x16x32_bf16 v[64:67], v[44:47], v[152:155], v[64:67]
  v_mfma_f32_16x16x32_bf16 v[68:71], v[44:47], v[156:159], v[68:71]
  v_mfma_f32_16x16x32_bf16 v[72:75], v[44:47], v[160:163], v[72:75]
  v_mfma_f32_16x16x32_bf16 v[76:79], v[44:47], v[164:167], v[76:79]
L_BV4a:
  s_cmp_eq_u32 s73, 0
  s_cbranch_scc1 L_BV4b
  s_and_b32 s30, s29, s20
  s_lshl_b32 s30, s30, 17
  s_add_u32 s30, s30, s88
  v_lshrrev_b32 v8, 1, v1
  buffer_load_dwordx4 v[32:35], v1, s[4:7], s30 offen offset:0 sc1
  buffer_load_dwordx2 v[36:37], v8, s[4:7], s30 offen offset:1024 sc1
  v_mov_b32 v38, 0
  v_mov_b32 v39, 0
  buffer_load_dwordx4 v[40:43], v1, s[4:7], s30 offen offset:2048 sc1
  buffer_load_dwordx2 v[44:45], v8, s[4:7], s30 offen offset:3072 sc1
  v_mov_b32 v46, 0
  v_mov_b32 v47, 0
L_BV4b:
  s_cmp_eq_u32 s72, 0
  s_cbranch_scc1 L_BV4
  s_and_b32 s30, s28, 7
  s_lshl_b32 s30, s30, 21
  s_add_u32 s30, s30, s79
  s_nop 3
  v_cvt_pk_bf16_f32 v16, v48, v49
  v_cvt_pk_bf16_f32 v17, v50, v51
  v_cvt_pk_bf16_f32 v18, v64, v65
  v_cvt_pk_bf16_f32 v19, v66, v67
  v_cvt_pk_bf16_f32 v20, v52, v53
  v_cvt_pk_bf16_f32 v21, v54, v55
  v_cvt_pk_bf16_f32 v22, v68, v69
  v_cvt_pk_bf16_f32 v23, v70, v71
  v_cvt_pk_bf16_f32 v24, v56, v57
  v_cvt_pk_bf16_f32 v25, v58, v59
  v_cvt_pk_bf16_f32 v26, v72, v73
  v_cvt_pk_bf16_f32 v27, v74, v75
  v_cvt_pk_bf16_f32 v28, v60, v61
  v_cvt_pk_bf16_f32 v29, v62, v63
  v_cvt_pk_bf16_f32 v30, v76, v77
  v_cvt_pk_bf16_f32 v31, v78, v79
  s_cmp_eq_u32 s27, 0
  s_cbranch_scc0 LS_46
  buffer_store_dwordx4 v[16:19], v1, s[4:7], s30 offen offset:0
  buffer_store_dwordx4 v[20:23], v1, s[4:7], s30 offen offset:1024
  buffer_store_dwordx4 v[24:27], v1, s[4:7], s30 offen offset:2048
  buffer_store_dwordx4 v[28:31], v1, s[4:7], s30 offen offset:3072
LD_47:
L_BV4:
  s_cmp_eq_u32 s73, 0
  s_cbranch_scc1 L_BV4c
  s_and_b32 s30, s29, 7
  s_lshl_b32 s30, s30, 21
  s_add_u32 s30, s30, s79
  buffer_load_dwordx4 v[16:19], v1, s[4:7], s30 offen offset:0 sc1
  buffer_load_dwordx4 v[20:23], v1, s[4:7], s30 offen offset:1024 sc1
  buffer_load_dwordx4 v[24:27], v1, s[4:7], s30 offen offset:2048 sc1
  buffer_load_dwordx4 v[28:31], v1, s[4:7], s30 offen offset:3072 sc1
L_BV4c:
  s_waitcnt vmcnt(12)
  s_cmp_eq_u32 s89, 1
  s_cbranch_scc1 WV_48
  s_waitcnt vmcnt(0)
WV_48:
  s_cmp_eq_u32 s75, 0
  s_cbranch_scc1 F3_49
  s_mov_b64 exec, 0xf
  v_mov_b32 v9, s75
  v_lshlrev_b32 v10, 7, v1
  buffer_store_dword v9, v10, s[4:7], s84 offen sc1
  s_mov_b64 exec, -1
  s_mov_b32 s75, 0
F3_49:
  s_cmp_eq_u32 s73, 0
  s_cbranch_scc1 L_BV4d
  v_mfma_f32_16x16x32_bf16 v[48:51], v[80:83], v[104:107], 0
  v_mfma_f32_16x16x32_bf16 v[52:55], v[80:83], v[136:139], 0
  v_mfma_f32_16x16x32_bf16 v[56:59], v[80:83], v[108:111], 0
  v_mfma_f32_16x16x32_bf16 v[60:63], v[80:83], v[140:143], 0
  v_mfma_f32_16x16x32_bf16 v[64:67], v[80:83], v[112:115], 0
  v_mfma_f32_16x16x32_bf16 v[68:71], v[80:83], v[144:147], 0
  v_mfma_f32_16x16x32_bf16 v[72:75], v[80:83], v[116:119], 0
  v_mfma_f32_16x16x32_bf16 v[76:79], v[80:83], v[148:151], 0
  v_mfma_f32_16x16x32_bf16 v[48:51], v[84:87], v[120:123], v[48:51]
  v_mfma_f32_16x16x32_bf16 v[52:55], v[84:87], v[152:155], v[52:55]
  v_mfma_f32_16x16x32_bf16 v[56:59], v[84:87], v[124:127], v[56:59]
  v_mfma_f32_16x16x32_bf16 v[60:63], v[84:87], v[156:159], v[60:63]
  v_mfma_f32_16x16x32_bf16 v[64:67], v[84:87], v[128:131], v[64:67]
  v_mfma_f32_16x16x32_bf16 v[68:71], v[84:87], v[160:163], v[68:71]
  v_mfma_f32_16x16x32_bf16 v[72:75], v[84:87], v[132:135], v[72:75]
  v_mfma_f32_16x16x32_bf16 v[76:79], v[84:87], v[164:167], v[76:79]
L_BV4d:
  s_cmp_eq_u32 s74, 0
  s_cbranch_scc1 L_BV5
  v_lshlrev_b32 v96, 16, v92
  v_and_b32 v97, 0xffff0000, v92
  v_lshlrev_b32 v98, 16, v93
  v_and_b32 v99, 0xffff0000, v93
  v_lshlrev_b32 v100, 16, v94
  v_and_b32 v101, 0xffff0000, v94
  v_lshlrev_b32 v102, 16, v95
  v_and_b32 v103, 0xffff0000, v95
  v_sub_f32 v91, 1.0, v90
  v_cvt_pk_bf16_f32 v91, v91, v91
  v_lshlrev_b32 v91, 16, v91
  v_and_b32 v89, 0xffff0000, v88
  v_lshlrev_b32 v88, 16, v88
  v_permlane32_swap_b32 v96, v98
  v_permlane32_swap_b32 v97, v99
  s_nop 1
  v_add_f32 v96, v96, v98
  v_add_f32 v97, v97, v99
  s_nop 1
  v_permlane16_swap_b32 v96, v97
  s_nop 1
  v_add_f32 v96, v96, v97
  s_nop 1
  v_add_f32_dpp v97, v96, v96 row_ror:8 row_mask:0xf bank_mask:0xf
  v_permlane32_swap_b32 v100, v102
  v_permlane32_swap_b32 v101, v103
  s_nop 1
  v_add_f32 v100, v100, v102
  v_add_f32 v101, v101, v103
  s_nop 1
  v_permlane16_swap_b32 v100, v101
  s_nop 1
  v_add_f32 v100, v100, v101
  s_nop 1
  v_add_f32_dpp v101, v100, v100 row_ror:8 row_mask:0xf bank_mask:0xf
  v_cvt_pk_bf16_f32 v92, v97, v101
  v_lshlrev_b32 v96, 16, v92
  v_and_b32 v100, 0xffff0000, v92
  v_mul_f32 v96, v90, v96
  v_mul_f32 v100, v90, v100
  v_mul_f32 v97, v91, v88
  v_mul_f32 v101, v91, v89
  v_cvt_pk_bf16_f32 v98, v96, v100
  v_cvt_pk_bf16_f32 v99, v97, v101
  v_lshlrev_b32 v96, 16, v98
  v_and_b32 v100, 0xffff0000, v98
  v_lshlrev_b32 v97, 16, v99
  v_and_b32 v101, 0xffff0000, v99
  v_add_f32 v96, v96, v97
  v_add_f32 v100, v100, v101
  v_cvt_pk_bf16_f32 v93, v96, v100
  s_mov_b64 exec, s[90:91]
  s_add_u32 s30, s87, 9437184
  s_cmp_eq_u32 s100, s76
  s_cbranch_scc1 L_AO1
  s_cmp_lg_u32 s100, s77
  s_cbranch_scc1 L_AO2
L_AO1:
  buffer_store_dword v92, v12, s[4:7], s30 offen
L_AO2:
  buffer_store_dword v93, v12, s[16:19], s87 offen
  s_mov_b64 exec, -1
  s_add_u32 s100, s100, 1
L_BV5:
  s_waitcnt vmcnt(1)
  s_cmp_eq_u32 s74, 1
  s_cbranch_scc1 W5_50
  s_waitcnt vmcnt(0)
W5_50:
  s_cmp_eq_u32 s72, 0
  s_cbranch_scc1 L_BVF1
  s_add_u32 s28, s28, 1
  s_mov_b64 exec, 1
  v_mov_b32 v9, s28
  v_mov_b32 v10, 0
  s_cmp_eq_u32 s27, 0
  s_cbranch_scc0 LS_51
  buffer_store_dword v9, v10, s[4:7], s85 offen
LD_52:
  s_mov_b64 exec, -1
L_BVF1:
  s_mov_b32 s86, s29
  s_add_u32 s29, s29, s73
  v_mov_b32 v5, v3
  v_mov_b32 v4, 0
  s_add_u32 s30, s28, 1
  s_mov_b64 exec, 0xff
  v_mov_b32 v4, s30
  s_add_u32 s30, s101, 1
  s_mov_b64 exec, 0xff00
  v_mov_b32 v4, s30
  s_add_u32 s30, s29, 1
  s_mov_b64 exec, 0x3ff0000
  v_mov_b32 v4, s30
  s_min_u32 s30, s29, 63
  s_lshl_b32 s30, s30, 3
  s_mov_b64 exec, 0x3000000
  v_add_u32 v5, s30, v3
  s_min_u32 s30, s100, 63
  s_lshl_b32 s30, s30, 4
  s_mov_b64 exec, 0x4000000
  v_add_u32 v5, s30, v3
  s_add_u32 s30, s100, 1
  s_mov_b32 exec_hi, 0xffff
  v_mov_b32 v4, s30
  s_mov_b64 exec, -1
  buffer_load_dword v6, v5, s[4:7], 0 offen sc1
  s_cmp_eq_u32 s73, 0
  s_cbranch_scc1 L_BV6w
  v_cvt_pk_bf16_f32 v80, v48, v49
  v_cvt_pk_bf16_f32 v81, v50, v51
  v_mov_b32 v82, 0
  v_mov_b32 v83, 0
  v_cvt_pk_bf16_f32 v84, v56, v57
  v_cvt_pk_bf16_f32 v85, v58, v59
  v_mov_b32 v86, 0
  v_mov_b32 v87, 0
  v_cvt_pk_bf16_f32 v88, v64, v65
  v_cvt_pk_bf16_f32 v89, v66, v67
  v_mov_b32 v90, 0
  v_mov_b32 v91, 0
  v_cvt_pk_bf16_f32 v92, v72, v73
  v_cvt_pk_bf16_f32 v93, v74, v75
  v_mov_b32 v94, 0
  v_mov_b32 v95, 0
  s_mov_b64 exec, s[94:95]
  v_cvt_pk_bf16_f32 v80, v52, v53
  v_cvt_pk_bf16_f32 v81, v54, v55
  v_cvt_pk_bf16_f32 v84, v60, v61
  v_cvt_pk_bf16_f32 v85, v62, v63
  v_cvt_pk_bf16_f32 v88, v68, v69
  v_cvt_pk_bf16_f32 v89, v70, v71
  v_cvt_pk_bf16_f32 v92, v76, v77
  v_cvt_pk_bf16_f32 v93, v78, v79
  s_mov_b64 exec, -1
  s_nop 1
  v_mfma_f32_16x16x32_bf16 v[48:51], v[32:35], v[16:19], 0
  v_mfma_f32_16x16x32_bf16 v[52:55], v[32:35], v[20:23], 0
  v_mfma_f32_16x16x32_bf16 v[56:59], v[32:35], v[24:27], 0
  v_mfma_f32_16x16x32_bf16 v[60:63], v[32:35], v[28:31], 0
  v_mfma_f32_16x16x32_bf16 v[64:67], v[40:43], v[16:19], 0
  v_mfma_f32_16x16x32_bf16 v[68:71], v[40:43], v[20:23], 0
  v_mfma_f32_16x16x32_bf16 v[72:75], v[40:43], v[24:27], 0
  v_mfma_f32_16x16x32_bf16 v[76:79], v[40:43], v[28:31], 0
  v_mfma_f32_16x16x32_bf16 v[48:51], v[36:39], v[80:83], v[48:51]
  v_mfma_f32_16x16x32_bf16 v[52:55], v[36:39], v[84:87], v[52:55]
  v_mfma_f32_16x16x32_bf16 v[56:59], v[36:39], v[88:91], v[56:59]
  v_mfma_f32_16x16x32_bf16 v[60:63], v[36:39], v[92:95], v[60:63]
  v_mfma_f32_16x16x32_bf16 v[64:67], v[44:47], v[80:83], v[64:67]
  v_mfma_f32_16x16x32_bf16 v[68:71], v[44:47], v[84:87], v[68:71]
  v_mfma_f32_16x16x32_bf16 v[72:75], v[44:47], v[88:91], v[72:75]
  v_mfma_f32_16x16x32_bf16 v[76:79], v[44:47], v[92:95], v[76:79]
  v_mov_b32 v9, 48
  s_max_i32 s31, s86, 1
  s_sub_u32 s31, s31, 1
L_OCP:
  ds_read_b128 v[16:19], v9
  s_waitcnt lgkmcnt(0)
  v_min3_u32 v10, v16, v17, v18
  v_min_u32 v10, v10, v19
  v_cmp_gt_u32 vcc, s31, v10
  s_cbranch_vccz L_OCK
  s_add_u32 s67, s67, 1
  s_cmp_lt_u32 s67, 524288
  s_cbranch_scc1 L_OCP
  s_branch L_END
L_OCK:
  v_mov_b32 v11, s29
  s_and_b32 s30, s86, 1
  s_lshl_b32 s30, s30, 14
  v_add_u32 v8, s30, v14
  v_cvt_pk_bf16_f32 v48, v48, v49
  v_cvt_pk_bf16_f32 v49, v50, v51
  ds_write_b64 v8, v[48:49] offset:0
  v_cvt_pk_bf16_f32 v52, v52, v53
  v_cvt_pk_bf16_f32 v53, v54, v55
  ds_write_b64 v8, v[52:53] offset:2048
  v_cvt_pk_bf16_f32 v56, v56, v57
  v_cvt_pk_bf16_f32 v57, v58, v59
  ds_write_b64 v8, v[56:57] offset:4096
  v_cvt_pk_bf16_f32 v60, v60, v61
  v_cvt_pk_bf16_f32 v61, v62, v63
  ds_write_b64 v8, v[60:61] offset:6144
  v_cvt_pk_bf16_f32 v64, v64, v65
  v_cvt_pk_bf16_f32 v65, v66, v67
  ds_write_b64 v8, v[64:65] offset:8192
  v_cvt_pk_bf16_f32 v68, v68, v69
  v_cvt_pk_bf16_f32 v69, v70, v71
  ds_write_b64 v8, v[68:69] offset:10240
  v_cvt_pk_bf16_f32 v72, v72, v73
  v_cvt_pk_bf16_f32 v73, v74, v75
  ds_write_b64 v8, v[72:73] offset:12288
  v_cvt_pk_bf16_f32 v76, v76, v77
  v_cvt_pk_bf16_f32 v77, v78, v79
  ds_write_b64 v8, v[76:77] offset:14336
  ds_write_b32 v2, v11 offset:32
L_BV6w:
L_TRYRED:
  s_cmp_ge_u32 s99, s29
  s_cbranch_scc1 L_NORED
  v_mov_b32 v9, 32
  ds_read_b128 v[16:19], v9
  ds_read_b128 v[24:27], v1 offset:1024
  ds_read_b128 v[28:31], v1 offset:2048
  s_and_b32 s30, s99, 1
  s_lshl_b32 s30, s30, 14
  s_lshl_b32 s31, s64, 12
  s_add_u32 s30, s30, s31
  s_add_u32 s30, s30, 101376
  v_add_u32 v10, s30, v1
  ds_read_b128 v[48:51], v10 offset:0
  ds_read_b128 v[52:55], v10 offset:1024
  ds_read_b128 v[56:59], v10 offset:2048
  ds_read_b128 v[60:63], v10 offset:3072
  s_waitcnt lgkmcnt(0)
  v_min3_u32 v8, v16, v17, v18
  v_min_u32 v8, v8, v19
  v_cmp_ge_u32 vcc, s99, v8
  s_cbranch_vccnz L_NORED
  s_cmp_eq_u32 s75, 0
  s_cbranch_scc1 L_RD1
  s_waitcnt vmcnt(0)
  s_cmp_eq_u32 s75, 0
  s_cbranch_scc1 F3_53
  s_mov_b64 exec, 0xf
  v_mov_b32 v9, s75
  v_lshlrev_b32 v10, 7, v1
  buffer_store_dword v9, v10, s[4:7], s84 offen sc1
  s_mov_b64 exec, -1
  s_mov_b32 s75, 0
F3_53:
L_RD1:
  s_lshl_b32 s30, s99, 19
  s_add_u32 s30, s30, s80
  s_add_u32 s99, s99, 1
  v_mov_b32 v11, s99
  ds_write_b32 v2, v11 offset:48
  v_mfma_f32_16x16x32_bf16 v[64:67], v[24:27], v[48:51], 0
  v_mfma_f32_16x16x32_bf16 v[64:67], v[28:31], v[52:55], v[64:67]
  v_mfma_f32_16x16x32_bf16 v[68:71], v[24:27], v[56:59], 0
  v_mfma_f32_16x16x32_bf16 v[68:71], v[28:31], v[60:63], v[68:71]
  s_nop 6
  v_cvt_pk_bf16_f32 v64, v64, v65
  v_cvt_pk_bf16_f32 v65, v66, v67
  buffer_store_dwordx2 v[64:65], v7, s[4:7], s30 offen offset:0 sc1
  v_cvt_pk_bf16_f32 v68, v68, v69
  v_cvt_pk_bf16_f32 v69, v70, v71
  buffer_store_dwordx2 v[68:69], v7, s[4:7], s30 offen offset:128 sc1
  s_mov_b32 s75, s99
  s_waitcnt vmcnt(2)
  s_branch L_BV6
L_NORED:
  s_waitcnt vmcnt(0)
L_BV6:
  s_branch L_BV_LOOP
L_BVEND:
  s_waitcnt vmcnt(0)
  s_mov_b32 s72, s62
  s_mov_b32 s73, s63
  s_bfe_u32 s30, s72, 0x30002
  s_cmp_lg_u32 s30, s25
  s_cbranch_scc1 L_FXE0
  s_lshr_b32 s30, s71, 1
  s_lshl_b32 s31, s30, 9
  s_and_b32 s65, s71, 1
  s_lshl_b32 s65, s65, 2
  s_add_u32 s65, s65, s64
  s_lshl_b32 s66, s65, 2
  s_add_u32 s31, s31, s66
  s_add_u32 s31, s31, 1626112
  v_and_b32 v8, 15, v0
  v_lshlrev_b32 v9, 5, v8
L_FY0:
  buffer_load_dword v10, v9, s[4:7], s31 offen sc1
  s_waitcnt vmcnt(0)
  v_cmp_eq_u32 vcc, 0, v10
  s_cbranch_vccz L_FY0K
  s_sleep 2
  s_add_u32 s67, s67, 1
  s_cmp_lt_u32 s67, 524288
  s_cbranch_scc1 L_FY0
  s_branch L_END
L_FY0K:
  v_lshrrev_b32 v9, 4, v0
  v_lshlrev_b32 v9, 10, v9
  v_lshlrev_b32 v10, 2, v8
  v_add_u32 v9, v9, v10
  s_lshl_b32 s31, s30, 14
  s_lshl_b32 s66, s65, 7
  s_add_u32 s31, s31, s66
  s_add_u32 s31, s31, 8519680
  s_add_u32 s66, s31, 0
  buffer_load_dword v16, v9, s[4:7], s66 offen sc1
  s_add_u32 s66, s31, 4096
  buffer_load_dword v17, v9, s[4:7], s66 offen sc1
  s_add_u32 s66, s31, 8192
  buffer_load_dword v18, v9, s[4:7], s66 offen sc1
  s_add_u32 s66, s31, 12288
  buffer_load_dword v19, v9, s[4:7], s66 offen sc1
  s_lshl_b32 s31, s72, 11
  s_lshl_b32 s66, s71, 7
  s_add_u32 s31, s31, s66
  s_lshl_b32 s66, s64, 5
  s_add_u32 s31, s31, s66
  v_lshlrev_b32 v10, 1, v8
  s_add_u32 s66, s31, 9437184
  buffer_load_ushort v20, v10, s[8:11], s31 offen
  buffer_load_ushort v21, v10, s[4:7], s66 offen sc1
  s_lshl_b32 s66, s72, 2
  s_add_u32 s66, s66, 8388608
  v_mov_b32 v11, 0
  buffer_load_dword v22, v11, s[4:7], s66 offen sc1
  s_add_u32 s66, s66, 8192
  buffer_load_dword v23, v11, s[4:7], s66 offen sc1
  s_waitcnt vmcnt(0)
  v_add_f32 v16, v16, v17
  v_add_f32 v18, v18, v19
  v_add_f32 v16, v16, v18
  v_mov_b32 v17, v16
  s_nop 1
  v_permlane16_swap_b32 v16, v17
  s_nop 1
  v_add_f32 v16, v16, v17
  v_mov_b32 v17, v16
  s_nop 1
  v_permlane32_swap_b32 v16, v17
  s_nop 1
  v_add_f32 v16, v16, v17
  v_cvt_pk_bf16_f32 v16, v16, v16
  v_lshlrev_b32 v16, 16, v16
  v_mul_f32 v23, 0xbfb8aa3b, v23
  v_exp_f32 v23, v23
  s_nop 0
  v_add_f32 v23, 1.0, v23
  v_rcp_f32 v23, v23
  s_nop 0
  v_cvt_pk_bf16_f32 v23, v23, v23
  v_lshlrev_b32 v23, 16, v23
  v_mul_f32 v16, v16, v23
  v_cvt_pk_bf16_f32 v16, v16, v16
  v_lshlrev_b32 v16, 16, v16
  v_lshlrev_b32 v20, 16, v20
  v_lshlrev_b32 v21, 16, v21
  v_add_f32 v16, v16, v20
  v_cvt_pk_bf16_f32 v16, v16, v16
  v_lshlrev_b32 v16, 16, v16
  v_sub_f32 v17, 1.0, v22
  v_cvt_pk_bf16_f32 v17, v17, v17
  v_lshlrev_b32 v17, 16, v17
  v_mul_f32 v21, v22, v21
  v_cvt_pk_bf16_f32 v21, v21, v21
  v_lshlrev_b32 v21, 16, v21
  v_mul_f32 v16, v17, v16
  v_cvt_pk_bf16_f32 v16, v16, v16
  v_lshlrev_b32 v16, 16, v16
  v_add_f32 v16, v16, v21
  v_cvt_pk_bf16_f32 v16, v16, v16
  s_mov_b64 exec, 0xffff
  buffer_store_short v16, v10, s[16:19], s31 offen
  s_mov_b64 exec, -1
L_FXE0:
  s_bfe_u32 s30, s73, 0x30002
  s_cmp_lg_u32 s30, s25
  s_cbranch_scc1 L_FXE1
  s_lshr_b32 s30, s71, 1
  s_lshl_b32 s31, s30, 9
  s_and_b32 s65, s71, 1
  s_lshl_b32 s65, s65, 2
  s_add_u32 s65, s65, s64
  s_lshl_b32 s66, s65, 2
  s_add_u32 s31, s31, s66
  s_add_u32 s31, s31, 1626112
  v_and_b32 v8, 15, v0
  v_lshlrev_b32 v9, 5, v8
L_FY1:
  buffer_load_dword v10, v9, s[4:7], s31 offen sc1
  s_waitcnt vmcnt(0)
  v_cmp_eq_u32 vcc, 0, v10
  s_cbranch_vccz L_FY1K
  s_sleep 2
  s_add_u32 s67, s67, 1
  s_cmp_lt_u32 s67, 524288
  s_cbranch_scc1 L_FY1
  s_branch L_END
L_FY1K:
  v_lshrrev_b32 v9, 4, v0
  v_lshlrev_b32 v9, 10, v9
  v_lshlrev_b32 v10, 2, v8
  v_add_u32 v9, v9, v10
  s_lshl_b32 s31, s30, 14
  s_lshl_b32 s66, s65, 7
  s_add_u32 s31, s31, s66
  s_add_u32 s31, s31, 8519744
  s_add_u32 s66, s31, 0
  buffer_load_dword v16, v9, s[4:7], s66 offen sc1
  s_add_u32 s66, s31, 4096
  buffer_load_dword v17, v9, s[4:7], s66 offen sc1
  s_add_u32 s66, s31, 8192
  buffer_load_dword v18, v9, s[4:7], s66 offen sc1
  s_add_u32 s66, s31, 12288
  buffer_load_dword v19, v9, s[4:7], s66 offen sc1
  s_lshl_b32 s31, s73, 11
  s_lshl_b32 s66, s71, 7
  s_add_u32 s31, s31, s66
  s_lshl_b32 s66, s64, 5
  s_add_u32 s31, s31, s66
  v_lshlrev_b32 v10, 1, v8
  s_add_u32 s66, s31, 9437184
  buffer_load_ushort v20, v10, s[8:11], s31 offen
  buffer_load_ushort v21, v10, s[4:7], s66 offen sc1
  s_lshl_b32 s66, s73, 2
  s_add_u32 s66, s66, 8388608
  v_mov_b32 v11, 0
  buffer_load_dword v22, v11, s[4:7], s66 offen sc1
  s_add_u32 s66, s66, 8192
  buffer_load_dword v23, v11, s[4:7], s66 offen sc1
  s_waitcnt vmcnt(0)
  v_add_f32 v16, v16, v17
  v_add_f32 v18, v18, v19
  v_add_f32 v16, v16, v18
  v_mov_b32 v17, v16
  s_nop 1
  v_permlane16_swap_b32 v16, v17
  s_nop 1
  v_add_f32 v16, v16, v17
  v_mov_b32 v17, v16
  s_nop 1
  v_permlane32_swap_b32 v16, v17
  s_nop 1
  v_add_f32 v16, v16, v17
  v_cvt_pk_bf16_f32 v16, v16, v16
  v_lshlrev_b32 v16, 16, v16
  v_mul_f32 v23, 0xbfb8aa3b, v23
  v_exp_f32 v23, v23
  s_nop 0
  v_add_f32 v23, 1.0, v23
  v_rcp_f32 v23, v23
  s_nop 0
  v_cvt_pk_bf16_f32 v23, v23, v23
  v_lshlrev_b32 v23, 16, v23
  v_mul_f32 v16, v16, v23
  v_cvt_pk_bf16_f32 v16, v16, v16
  v_lshlrev_b32 v16, 16, v16
  v_lshlrev_b32 v20, 16, v20
  v_lshlrev_b32 v21, 16, v21
  v_add_f32 v16, v16, v20
  v_cvt_pk_bf16_f32 v16, v16, v16
  v_lshlrev_b32 v16, 16, v16
  v_sub_f32 v17, 1.0, v22
  v_cvt_pk_bf16_f32 v17, v17, v17
  v_lshlrev_b32 v17, 16, v17
  v_mul_f32 v21, v22, v21
  v_cvt_pk_bf16_f32 v21, v21, v21
  v_lshlrev_b32 v21, 16, v21
  v_mul_f32 v16, v17, v16
  v_cvt_pk_bf16_f32 v16, v16, v16
  v_lshlrev_b32 v16, 16, v16
  v_add_f32 v16, v16, v21
  v_cvt_pk_bf16_f32 v16, v16, v16
  s_mov_b64 exec, 0xffff
  buffer_store_short v16, v10, s[16:19], s31 offen
  s_mov_b64 exec, -1
L_FXE1:
  s_waitcnt vmcnt(0) lgkmcnt(0)
  s_endpgm
L_CR0:
  s_waitcnt vmcnt(0)
  s_add_u32 s68, s68, 1
  s_add_u32 s67, s67, 1
  s_cmp_ge_u32 s67, 524288
  s_cbranch_scc1 L_END
  buffer_load_dwordx4 v[8:11], v0, s[4:7], s84 offen offset:0 sc1
  buffer_load_dwordx4 v[12:15], v0, s[4:7], s84 offen offset:1024 sc1
  s_branch L_CW0
L_CR1:
  s_waitcnt vmcnt(0)
  s_add_u32 s68, s68, 1
  s_add_u32 s67, s67, 1
  s_cmp_ge_u32 s67, 524288
  s_cbranch_scc1 L_END
  buffer_load_dwordx4 v[12:15], v0, s[4:7], s84 offen offset:1024 sc1
  s_branch L_CW1
L_VR0:
  s_waitcnt vmcnt(0)
  s_add_u32 s68, s68, 1024
  s_add_u32 s67, s67, 1
  s_cmp_ge_u32 s67, 524288
  s_cbranch_scc1 L_END
  buffer_load_dwordx4 v[8:11], v1, s[4:7], s85 offen sc1
  s_branch L_VW0
L_AR0:
  s_waitcnt vmcnt(0)
  s_add_u32 s68, s68, 1024
  s_add_u32 s67, s67, 1
  s_cmp_ge_u32 s67, 524288
  s_cbranch_scc1 L_END
  buffer_load_dwordx4 v[64:67], v1, s[4:7], s82 offen offset:0 sc1
  buffer_load_dwordx4 v[68:71], v1, s[4:7], s82 offen offset:1024 sc1
  buffer_load_dwordx4 v[72:75], v1, s[4:7], s82 offen offset:2048 sc1
  buffer_load_dwordx4 v[76:79], v1, s[4:7], s82 offen offset:3072 sc1
  s_branch L_AW0
L_AR1:
  s_waitcnt vmcnt(0)
  s_add_u32 s68, s68, 1024
  s_add_u32 s67, s67, 1
  s_cmp_ge_u32 s67, 524288
  s_cbranch_scc1 L_END
  buffer_load_dwordx4 v[68:71], v1, s[4:7], s82 offen offset:1024 sc1
  buffer_load_dwordx4 v[72:75], v1, s[4:7], s82 offen offset:2048 sc1
  buffer_load_dwordx4 v[76:79], v1, s[4:7], s82 offen offset:3072 sc1
  s_branch L_AW1
L_AR2:
  s_waitcnt vmcnt(0)
  s_add_u32 s68, s68, 1024
  s_add_u32 s67, s67, 1
  s_cmp_ge_u32 s67, 524288
  s_cbranch_scc1 L_END
  buffer_load_dwordx4 v[72:75], v1, s[4:7], s82 offen offset:2048 sc1
  buffer_load_dwordx4 v[76:79], v1, s[4:7], s82 offen offset:3072 sc1
  s_branch L_AW2
L_AR3:
  s_waitcnt vmcnt(0)
  s_add_u32 s68, s68, 1024
  s_add_u32 s67, s67, 1
  s_cmp_ge_u32 s67, 524288
  s_cbranch_scc1 L_END
  buffer_load_dwordx4 v[76:79], v1, s[4:7], s82 offen offset:3072 sc1
  s_branch L_AW3
LS_1:
  buffer_store_dwordx2 v[36:37], v38, s[4:7], s89 offen sc1
  s_branch LD_2
LS_3:
  buffer_store_dwordx2 v[36:37], v38, s[4:7], s31 offen sc1
  buffer_store_dwordx2 v[6:7], v38, s[4:7], s30 offen sc1
  s_branch LD_4
LS_5:
  s_sleep 40
  buffer_store_dword v4, v6, s[4:7], s100 offen sc1
  s_branch LD_6
LS_7:
  buffer_store_dwordx2 v[8:9], v5, s[4:7], s30 offen sc1
  s_mov_b64 exec, s[92:93]
  buffer_store_dwordx2 v[8:9], v6, s[4:7], s31 offen sc1
  s_branch LD_8
LS_9:
  buffer_store_dwordx2 v[18:19], v5, s[4:7], s83 offen sc1
  s_branch LD_10
LS_11:
  buffer_store_dwordx2 v[18:19], v5, s[4:7], s74 offen sc1
  s_branch LD_12
LS_13:
  buffer_store_dwordx2 v[8:9], v10, s[4:7], s63 offen sc1
  s_branch LD_14
LS_16:
  s_sleep 40
  buffer_store_dword v4, v8, s[4:7], s100 offen sc1
  s_branch LD_17
LS_19:
  s_sleep 40
  buffer_store_dword v4, v8, s[4:7], s100 offen sc1
  s_branch LD_20
LS_21:
  buffer_store_dwordx2 v[100:101], v6, s[4:7], s85 offen sc1
  s_branch LD_22
LS_24:
  s_sleep 40
  buffer_store_dword v9, v8, s[4:7], s83 offen sc1
  s_branch LD_25
LS_27:
  s_sleep 40
  buffer_store_dword v9, v8, s[4:7], s83 offen sc1
  s_branch LD_28
LS_30:
  s_sleep 40
  buffer_store_dword v9, v8, s[4:7], s83 offen sc1
  s_branch LD_31
LS_32:
  buffer_store_dwordx2 v[32:33], v4, s[4:7], s31 offen sc1
  buffer_store_dwordx2 v[36:37], v4, s[4:7], s30 offen sc1
  s_branch LD_33
LS_35:
  s_sleep 40
  buffer_store_dword v9, v8, s[4:7], s83 offen sc1
  s_branch LD_36
LS_38:
  s_sleep 40
  buffer_store_dword v9, v8, s[4:7], s83 offen sc1
  s_branch LD_39
LS_40:
  buffer_store_dwordx4 v[28:31], v1, s[4:7], s66 offen sc1
  buffer_store_dwordx2 v[32:33], v8, s[4:7], s66 offen offset:1024 sc1
  s_branch LD_41
LS_42:
  s_sleep 40
  buffer_store_dword v8, v9, s[4:7], s30 offen sc1
  s_branch LD_43
LS_46:
  buffer_store_dwordx4 v[16:19], v1, s[4:7], s30 offen offset:0 sc1
  buffer_store_dwordx4 v[20:23], v1, s[4:7], s30 offen offset:1024 sc1
  buffer_store_dwordx4 v[24:27], v1, s[4:7], s30 offen offset:2048 sc1
  buffer_store_dwordx4 v[28:31], v1, s[4:7], s30 offen offset:3072 sc1
  s_branch LD_47
LS_51:
  s_sleep 40
  buffer_store_dword v9, v10, s[4:7], s85 offen sc1
  s_branch LD_52
L_END:
  s_endpgm
.set CODE_BYTES, L_END-gated_mix__memory_aug_recurrent_mem_tr__moe_arch_mod__prompt_kernel-256
.section .rodata,"a"
.p2align 6
.amdhsa_kernel gated_mix__memory_aug_recurrent_mem_tr__moe_arch_mod__prompt_kernel
  .amdhsa_next_free_vgpr 168
  .amdhsa_next_free_sgpr 102
  .amdhsa_accum_offset 168
  .amdhsa_group_segment_fixed_size 0
  .amdhsa_kernarg_size 128
  .amdhsa_user_sgpr_count 2
  .amdhsa_user_sgpr_kernarg_segment_ptr 1
  .amdhsa_system_sgpr_workgroup_id_x 1
.end_amdhsa_kernel
```
